```python
import torch

def _softmax(x, axis=-1):
    return torch.softmax(x, dim=axis)
def _gelu(x):
    return torch.nn.functional.gelu(x, approximate="tanh")
def _silu(x):
    return torch.nn.functional.silu(x)
def _sigmoid(x):
    return torch.sigmoid(x)
def _layernorm(x, axis=-1, eps=1e-5):
    m = x.mean(dim=axis, keepdim=True)
    v = x.var(dim=axis, keepdim=True, unbiased=False)
    return (x - m) / torch.sqrt(v + eps)
def _scatter_add(tgt, idx, src, axis=0):
    return tgt.clone().index_add_(axis, idx, src)
def _segment_sum(src, seg, n):
    out = torch.zeros((n,) + src.shape[1:], dtype=src.dtype)
    return out.index_add_(0, seg, src)
def _pad(x, pw):
    flat = tuple(v for pair in reversed(pw) for v in pair)
    return torch.nn.functional.pad(x, flat)

kernel_name = 'standalone__mixer_s_mlp__sampling'

def setup_inputs():

    _w = (lambda a: (lambda t: t.to(torch.bfloat16) if t.is_floating_point() else t)(torch.as_tensor(a)))
    B, S, D, F = 16, 32, 576, 4608
    return {
        "x":  _w((lambda *s: torch.randn(*s, dtype=torch.bfloat16) * 0.4)(B, S, D)),
        "w1": _w((lambda *s: torch.randn(*s, dtype=torch.bfloat16) * 3.2)(D, D) * (D ** -0.5)),
        "w2": _w((lambda *s: torch.randn(*s, dtype=torch.bfloat16) * 3.2)(D, D) * (D ** -0.5)),
        "w3": _w((lambda *s: torch.randn(*s, dtype=torch.bfloat16) * 3.2)(D, F) * (D ** -0.5)),
        "w4": _w((lambda *s: torch.randn(*s, dtype=torch.bfloat16) * 0.8)(F, D) * (F ** -0.5)),
    }

def reference(x, w1, w2, w3, w4):
    B, S, D = x.shape
    h = _gelu(_layernorm(x, axis=-1) @ w1)
    c = D // 4
    g0 = _pad(h[:, :, 0*c:1*c], ((0, 0), (1, 0), (0, 0)))[:, :S, :]
    g1 = _pad(h[:, :, 1*c:2*c], ((0, 0), (0, 1), (0, 0)))[:, 1:, :]
    g2 = _pad(h[:, :, 2*c:3*c], ((0, 0), (2, 0), (0, 0)))[:, :S, :]
    g3 = _pad(h[:, :, 3*c:   ], ((0, 0), (0, 2), (0, 0)))[:, 2:, :]
    hs = torch.concatenate([g0, g1, g2, g3], axis=-1) @ w2
    x1 = x + hs
    h2 = _gelu(_layernorm(x1, axis=-1) @ w3) @ w4
    return x1 + h2
```

```asm
; @launch grid=(256,1,1) block=(256,1,1) lds=163840
.amdgcn_target "amdgcn-amd-amdhsa--gfx950"
.text
.globl standalone__mixer_s_mlp__sampling_kernel
.p2align 8
.type standalone__mixer_s_mlp__sampling_kernel,@function
standalone__mixer_s_mlp__sampling_kernel:
    s_cmp_ge_u32 s2, 256
    s_cbranch_scc1 L_end
    s_load_dwordx2 s[8:9], s[0:1], 0
    s_load_dwordx2 s[12:13], s[0:1], 8
    s_load_dwordx2 s[16:17], s[0:1], 16
    s_load_dwordx2 s[20:21], s[0:1], 24
    s_load_dwordx2 s[24:25], s[0:1], 32
    s_load_dwordx2 s[28:29], s[0:1], 40
    s_load_dwordx2 s[32:33], s[0:1], 48
    s_load_dwordx2 s[36:37], s[0:1], 56
    v_lshrrev_b32 v6, 6, v0
    v_and_b32 v1, 63, v0
    v_readfirstlane_b32 s44, v6
    s_and_b32 s40, s2, 7
    s_lshr_b32 s41, s2, 3
    s_getpc_b64 s[4:5]
L_pc:
    s_lshl_b32 s50, s41, 2
    s_add_u32 s50, s50, s44
    s_lshl_b32 s50, s50, 8
    v_lshl_add_u32 v6, v1, 7, s50
    v_min_u32 v6, L_end-L_pc, v6
    s_mov_b64 exec, 3
    global_load_dword v18, v6, s[4:5]
    s_mov_b64 exec, -1
    s_mov_b32 s10, 589824
    s_mov_b32 s11, 0x20000
    s_mov_b32 s14, 663552
    s_mov_b32 s15, 0x20000
    s_lshl_b32 s66, s44, 10
    s_cmp_lt_u32 s41, 18
    s_cbranch_scc1 L_work
    s_sub_u32 s50, s41, 18
    s_mul_i32 s51, s44, 14
    s_add_u32 s81, s50, s51
    v_lshlrev_b32 v14, 7, v1
    s_lshl_b32 s82, s81, 13
    s_add_u32 s50, s82, 368640
    s_waitcnt lgkmcnt(0)
    buffer_load_dword v72, v14, s[12:15], s50 offen
    s_branch L_help
L_work:
    s_cmp_ge_u32 s41, 9
    s_cselect_b32 s45, 1, 0
    s_mul_i32 s82, s45, 9
    s_sub_u32 s46, s41, s82
    s_mul_i32 s80, s45, 5
    s_lshl_b32 s50, s40, 1
    s_add_u32 s50, s50, s45
    s_mul_i32 s69, s50, 36864
    s_lshl_b32 s51, s44, 3
    v_lshrrev_b32 v6, 3, v1
    v_add_u32 v6, s51, v6
    v_bfe_u32 v7, v6, 1, 3
    v_and_b32 v8, 7, v1
    v_xor_b32 v7, v7, v8
    v_mul_u32_u24 v9, 1152, v6
    v_lshl_add_u32 v24, v7, 4, v9
    s_and_b32 s51, s44, 1
    s_lshl_b32 s51, s51, 2
    v_lshrrev_b32 v7, 3, v1
    v_and_b32 v7, 2, v7
    v_or_b32 v7, s51, v7
    v_xor_b32 v7, v7, v8
    v_lshl_add_u32 v7, v7, 4, v9
    s_lshl_b32 s51, s46, 7
    v_add_u32 v20, s51, v7
    s_lshl_b32 s50, s46, 12
    s_add_u32 m0, s50, s66
    s_add_u32 s52, s51, s69
    s_waitcnt lgkmcnt(0)
    buffer_load_dwordx4 v24, s[8:11], s52 offen lds
    s_lshl_b32 s56, s80, 12
    s_add_u32 s56, s56, s66
    s_add_u32 m0, s56, 73728
    s_mul_i32 s54, s80, 36864
    buffer_load_dwordx4 v20, s[12:15], s54 offen lds
    s_add_u32 m0, m0, 4096
    s_add_u32 s54, s54, 36864
    buffer_load_dwordx4 v20, s[12:15], s54 offen lds
    s_add_u32 m0, m0, 4096
    s_add_u32 s54, s54, 36864
    buffer_load_dwordx4 v20, s[12:15], s54 offen lds
    s_add_u32 m0, m0, 4096
    s_add_u32 s54, s54, 36864
    buffer_load_dwordx4 v20, s[12:15], s54 offen lds
    s_add_u32 m0, m0, 4096
    s_add_u32 s54, s54, 36864
    buffer_load_dwordx4 v20, s[12:15], s54 offen lds
    s_sub_u32 s80, 5, s80
    s_sub_u32 s83, 9, s82
    s_mov_b32 s38, 268435456
    s_mov_b32 s39, 0x20000
    s_mov_b32 s18, 663552
    s_mov_b32 s19, 0x20000
    s_mov_b32 s22, 5308416
    s_mov_b32 s23, 0x20000
    s_mov_b32 s26, 5308416
    s_mov_b32 s27, 0x20000
    s_mov_b32 s30, 589824
    s_mov_b32 s31, 0x20000
    s_mov_b32 s34, 256
    s_mov_b32 s35, 0x20000
    v_lshlrev_b32 v2, 4, v1
    s_lshr_b32 s42, s41, 2
    s_and_b32 s43, s41, 3
    s_mul_i32 s67, s44, 4608
    s_lshl_b32 s50, s42, 15
    s_lshl_b32 s51, s40, 15
    v_mov_b32 v6, s50
    v_mov_b32 v7, s51
    buffer_load_dword v18, v6, s[36:39], 0 offen sc1
    buffer_load_dword v19, v7, s[36:39], 0 offen sc1
    s_lshl_b32 s57, s41, 3
    s_mov_b32 m0, s66
    s_add_u32 s57, s57, s40
    s_getreg_b32 s47, hwreg(HW_REG_XCC_ID)
    s_and_b32 s47, s47, 7
    s_cmp_eq_u32 s44, 0
    s_cselect_b32 s74, 1, 0
    s_mov_b32 s75, 0
    s_mov_b32 s72, 0xbdd2d3e8
    s_mov_b32 s73, 0xbdd2d3e8
    v_mov_b32 v4, 0xc0135761
    v_mov_b32 v5, 0xc0135761
    v_mov_b32 v60, 0x3f803f80
    v_mov_b32 v61, 0x3f803f80
    buffer_load_dwordx4 v24, s[8:11], s69 offen offset:0 lds
    s_add_u32 m0, m0, 3968
    v_mov_b32 v62, 0x3f803f80
    v_mov_b32 v63, 0x3f803f80
    v_lshrrev_b32 v6, 4, v1
    v_bfe_u32 v7, v1, 2, 2
    v_lshl_add_u32 v6, v6, 3, v7
    v_bfe_u32 v7, v1, 3, 2
    v_xor_b32 v7, s44, v7
    v_lshlrev_b32 v7, 5, v7
    v_lshl_add_u32 v6, v6, 7, v7
    v_and_b32 v7, 3, v1
    v_lshl_add_u32 v6, v7, 3, v6
    v_add_u32 v21, 36864, v6
    buffer_load_dwordx4 v24, s[8:11], s69 offen offset:128 lds
    s_add_u32 m0, m0, 3968
    v_add_u32 v22, 73728, v6
    v_add_u32 v23, 110592, v6
    v_and_b32 v6, 15, v1
    v_bfe_u32 v7, v1, 1, 3
    v_lshrrev_b32 v8, 4, v1
    v_xor_b32 v7, v7, v8
    v_lshlrev_b32 v7, 4, v7
    v_lshl_add_u32 v25, v6, 7, v7
    v_xor_b32 v26, 64, v25
    s_lshl_b32 s50, s46, 2
    s_add_u32 s50, s50, s44
    s_mov_b32 s51, 1
    buffer_load_dwordx4 v24, s[8:11], s69 offen offset:256 lds
    s_add_u32 m0, m0, 3968
    s_cmp_ge_u32 s50, 9
    s_cselect_b32 s51, -1, s51
    s_cmp_ge_u32 s50, 18
    s_cselect_b32 s51, 2, s51
    s_cmp_ge_u32 s50, 27
    s_cselect_b32 s51, -2, s51
    v_and_b32 v6, 31, v1
    v_add_u32 v6, s51, v6
    v_cmp_gt_u32 s[76:77], 32, v6
    v_and_b32 v7, 15, v6
    v_bfe_u32 v6, v6, 4, 1
    v_lshlrev_b32 v6, 10, v6
    v_lshl_add_u32 v6, v7, 4, v6
    v_lshrrev_b32 v7, 5, v1
    v_lshl_add_u32 v15, v7, 8, v6
    buffer_load_dwordx4 v24, s[8:11], s69 offen offset:384 lds
    s_add_u32 m0, m0, 3968
    v_and_b32 v8, 15, v1
    v_bfe_u32 v6, v1, 4, 1
    v_lshlrev_b32 v6, 10, v6
    v_lshl_add_u32 v6, v8, 4, v6
    v_lshl_add_u32 v16, v7, 8, v6
    s_lshr_b32 s51, s50, 1
    s_and_b32 s52, s50, 1
    s_lshl_b32 s52, s52, 9
    s_add_u32 s58, s82, s51
    s_sub_u32 s59, s58, 18
    s_cmp_ge_u32 s58, 18
    s_cselect_b32 s58, s59, s58
    s_lshl_b32 s78, s58, 11
    buffer_load_dwordx4 v24, s[8:11], s69 offen offset:512 lds
    s_add_u32 m0, m0, 3968
    s_add_u32 s78, s78, s52
    s_add_u32 s78, s78, s69
    s_add_u32 s78, s78, 262144
    s_lshl_b32 s79, s51, 12
    s_add_u32 s79, s79, s52
    s_lshl_b32 s52, s45, 11
    s_add_u32 s79, s79, s52
    s_mul_i32 s52, s40, 73728
    s_add_u32 s79, s79, s52
    s_add_u32 s79, s79, 1048576
    v_and_b32 v10, 15, v1
    v_bfe_u32 v11, v1, 1, 3
    buffer_load_dwordx4 v24, s[8:11], s69 offen offset:640 lds
    s_add_u32 m0, m0, 3968
    v_lshrrev_b32 v12, 5, v1
    s_lshl_b32 s50, s44, 1
    v_add_u32 v12, s50, v12
    v_xor_b32 v11, v11, v12
    v_lshlrev_b32 v11, 4, v11
    v_lshl_add_u32 v10, v10, 7, v11
    v_bfe_u32 v11, v1, 4, 1
    v_lshl_add_u32 v10, v11, 3, v10
    s_lshl_b32 s50, s46, 12
    v_add_u32 v17, s50, v10
    s_and_b32 s50, s44, 1
    s_lshl_b32 s50, s50, 2
    buffer_load_dwordx4 v24, s[8:11], s69 offen offset:768 lds
    s_add_u32 m0, m0, 3968
    s_lshr_b32 s51, s44, 1
    s_lshl_b32 s51, s51, 5
    s_add_u32 s50, s50, s51
    s_mul_i32 s52, s43, 288
    s_mul_i32 s51, s40, 1152
    s_add_u32 s51, s51, s52
    s_mul_i32 s70, s50, 9216
    s_add_u32 s70, s70, s51
    s_mul_i32 s51, s40, 663552
    s_add_u32 s51, s51, s52
    s_mul_i32 s87, s44, 165888
    s_add_u32 s87, s87, s51
    buffer_load_dwordx4 v24, s[8:11], s69 offen offset:896 lds
    s_add_u32 m0, m0, 3968
    s_add_u32 s87, s87, 147456
    s_mul_i32 s50, s44, 18432
    s_add_u32 s51, s51, s50
    s_add_u32 s50, s43, 0
    s_and_b32 s50, s50, 3
    s_mul_i32 s50, s50, 165888
    s_add_u32 s71, s50, s51
    s_add_u32 s50, s43, 1
    s_and_b32 s50, s50, 3
    s_mul_i32 s50, s50, 165888
    s_add_u32 s88, s50, s51
    s_add_u32 s50, s43, 2
    buffer_load_dwordx4 v24, s[8:11], s69 offen offset:1024 lds
    s_lshl_b32 s56, s80, 12
    s_add_u32 s56, s56, s66
    s_and_b32 s50, s50, 3
    s_add_u32 m0, s56, 73728
    s_mul_i32 s54, s80, 36864
    s_mul_i32 s50, s50, 165888
    s_add_u32 s89, s50, s51
    s_add_u32 s50, s43, 3
    s_and_b32 s50, s50, 3
    s_mul_i32 s50, s50, 165888
    s_add_u32 s3, s50, s51
    s_mov_b32 s50, -288
    s_movk_i32 s51, 9216
    s_movk_i32 s52, 1152
    v_mul_u32_u24 v8, 3641, v1
    v_lshrrev_b32 v7, 16, v8
    buffer_load_dwordx4 v20, s[12:15], s54 offen lds
    s_add_u32 m0, m0, 4096
    s_add_u32 s54, s54, 36864
    v_mad_i32_i24 v6, v7, s50, v2
    v_mad_u32_u24 v32, v7, s52, v6
    v_and_b32 v27, 12, v7
    v_add_u32 v7, v7, v27
    v_mad_u32_u24 v27, v7, s51, v6
    v_add_u32 v7, 116512, v8
    v_lshrrev_b32 v7, 16, v7
    v_mad_i32_i24 v6, v7, s50, v2
    v_mad_u32_u24 v33, v7, s52, v6
    v_and_b32 v28, 12, v7
    v_add_u32 v7, v7, v28
    v_mad_u32_u24 v28, v7, s51, v6
    buffer_load_dwordx4 v20, s[12:15], s54 offen lds
    s_add_u32 m0, m0, 4096
    s_add_u32 s54, s54, 36864
    v_add_u32 v7, 349536, v8
    v_lshrrev_b32 v7, 16, v7
    v_mad_i32_i24 v6, v7, s50, v2
    v_mad_u32_u24 v34, v7, s52, v6
    v_and_b32 v29, 12, v7
    v_add_u32 v7, v7, v29
    v_mad_u32_u24 v29, v7, s51, v6
    v_add_u32 v7, 582560, v8
    v_lshrrev_b32 v7, 16, v7
    v_mad_i32_i24 v6, v7, s50, v2
    v_mad_u32_u24 v35, v7, s52, v6
    v_and_b32 v30, 12, v7
    buffer_load_dwordx4 v20, s[12:15], s54 offen lds
    s_add_u32 m0, m0, 4096
    s_add_u32 s54, s54, 36864
    v_add_u32 v7, v7, v30
    v_mad_u32_u24 v30, v7, s51, v6
    v_add_u32 v7, 815584, v8
    v_lshrrev_b32 v7, 16, v7
    v_mad_i32_i24 v6, v7, s50, v2
    v_mad_u32_u24 v36, v7, s52, v6
    v_and_b32 v31, 12, v7
    v_add_u32 v7, v7, v31
    v_mad_u32_u24 v31, v7, s51, v6
    v_lshrrev_b32 v6, 2, v1
    v_mul_u32_u24 v6, 288, v6
    v_and_b32 v7, 3, v1
    buffer_load_dwordx4 v20, s[12:15], s54 offen lds
    s_add_u32 m0, m0, 4096
    s_add_u32 s54, s54, 36864
    v_lshl_add_u32 v6, v7, 3, v6
    s_lshl_b32 s50, s44, 6
    v_add_u32 v37, s50, v6
    v_add_u32 v40, 256, v6
    v_add_u32 v38, 55296, v37
    v_add_u32 v41, 55296, v40
    v_add_u32 v39, 110592, v37
    v_add_u32 v42, 110592, v40
    v_and_b32 v14, 0x38, v1
    s_lshl_b32 s50, s44, 6
    s_add_u32 s50, s50, 147456
    v_add_u32 v14, s50, v14
    buffer_load_dwordx4 v20, s[12:15], s54 offen lds
    v_add_u32 v6, s66, v2
    v_mov_b32 v10, 0
    v_mov_b32 v11, 0
    v_mov_b32 v12, 0
    v_mov_b32 v13, 0
    s_waitcnt vmcnt(5)
    ds_read_b128 v[72:75], v6 offset:0
    ds_read_b128 v[76:79], v6 offset:4096
    ds_read_b128 v[80:83], v6 offset:8192
    ds_read_b128 v[84:87], v6 offset:12288
    ds_read_b128 v[88:91], v6 offset:16384
    ds_read_b128 v[92:95], v6 offset:20480
    ds_read_b128 v[96:99], v6 offset:24576
    ds_read_b128 v[100:103], v6 offset:28672
    ds_read_b128 v[104:107], v6 offset:32768
    s_add_u32 m0, s66, 114688
    s_mov_b32 s54, 368640
    buffer_load_dwordx4 v20, s[12:15], s54 offen lds
    s_add_u32 m0, m0, 4096
    s_add_u32 s54, s54, 36864
    buffer_load_dwordx4 v20, s[12:15], s54 offen lds
    s_waitcnt lgkmcnt(8)
    v_dot2c_f32_bf16 v10, v72, v60
    v_dot2c_f32_bf16 v12, v72, v72
    v_dot2c_f32_bf16 v11, v73, v60
    v_dot2c_f32_bf16 v13, v73, v73
    v_dot2c_f32_bf16 v10, v74, v60
    v_dot2c_f32_bf16 v12, v74, v74
    v_dot2c_f32_bf16 v11, v75, v60
    v_dot2c_f32_bf16 v13, v75, v75
    s_add_u32 m0, m0, 4096
    s_add_u32 s54, s54, 36864
    buffer_load_dwordx4 v20, s[12:15], s54 offen lds
    s_waitcnt lgkmcnt(7)
    v_dot2c_f32_bf16 v10, v76, v60
    v_dot2c_f32_bf16 v12, v76, v76
    v_dot2c_f32_bf16 v11, v77, v60
    v_dot2c_f32_bf16 v13, v77, v77
    v_dot2c_f32_bf16 v10, v78, v60
    v_dot2c_f32_bf16 v12, v78, v78
    v_dot2c_f32_bf16 v11, v79, v60
    v_dot2c_f32_bf16 v13, v79, v79
    s_add_u32 m0, m0, 4096
    s_add_u32 s54, s54, 36864
    buffer_load_dwordx4 v20, s[12:15], s54 offen lds
    s_waitcnt lgkmcnt(6)
    v_dot2c_f32_bf16 v10, v80, v60
    v_dot2c_f32_bf16 v12, v80, v80
    v_dot2c_f32_bf16 v11, v81, v60
    v_dot2c_f32_bf16 v13, v81, v81
    v_dot2c_f32_bf16 v10, v82, v60
    v_dot2c_f32_bf16 v12, v82, v82
    v_dot2c_f32_bf16 v11, v83, v60
    v_dot2c_f32_bf16 v13, v83, v83
    s_add_u32 m0, m0, 4096
    s_add_u32 s54, s54, 36864
    buffer_load_dwordx4 v20, s[12:15], s54 offen lds
    s_waitcnt lgkmcnt(5)
    v_dot2c_f32_bf16 v10, v84, v60
    v_dot2c_f32_bf16 v12, v84, v84
    v_dot2c_f32_bf16 v11, v85, v60
    v_dot2c_f32_bf16 v13, v85, v85
    v_dot2c_f32_bf16 v10, v86, v60
    v_dot2c_f32_bf16 v12, v86, v86
    v_dot2c_f32_bf16 v11, v87, v60
    v_dot2c_f32_bf16 v13, v87, v87
    s_add_u32 m0, m0, 4096
    s_add_u32 s54, s54, 36864
    buffer_load_dwordx4 v20, s[12:15], s54 offen lds
    s_waitcnt lgkmcnt(4)
    v_dot2c_f32_bf16 v10, v88, v60
    v_dot2c_f32_bf16 v12, v88, v88
    v_dot2c_f32_bf16 v11, v89, v60
    v_dot2c_f32_bf16 v13, v89, v89
    v_dot2c_f32_bf16 v10, v90, v60
    v_dot2c_f32_bf16 v12, v90, v90
    v_dot2c_f32_bf16 v11, v91, v60
    v_dot2c_f32_bf16 v13, v91, v91
    s_add_u32 m0, m0, 4096
    s_add_u32 s54, s54, 36864
    buffer_load_dwordx4 v20, s[12:15], s54 offen lds
    s_waitcnt lgkmcnt(3)
    v_dot2c_f32_bf16 v10, v92, v60
    v_dot2c_f32_bf16 v12, v92, v92
    v_dot2c_f32_bf16 v11, v93, v60
    v_dot2c_f32_bf16 v13, v93, v93
    v_dot2c_f32_bf16 v10, v94, v60
    v_dot2c_f32_bf16 v12, v94, v94
    v_dot2c_f32_bf16 v11, v95, v60
    v_dot2c_f32_bf16 v13, v95, v95
    s_add_u32 m0, m0, 4096
    s_add_u32 s54, s54, 36864
    buffer_load_dwordx4 v20, s[12:15], s54 offen lds
    s_waitcnt lgkmcnt(2)
    v_dot2c_f32_bf16 v10, v96, v60
    v_dot2c_f32_bf16 v12, v96, v96
    v_dot2c_f32_bf16 v11, v97, v60
    v_dot2c_f32_bf16 v13, v97, v97
    v_dot2c_f32_bf16 v10, v98, v60
    v_dot2c_f32_bf16 v12, v98, v98
    v_dot2c_f32_bf16 v11, v99, v60
    v_dot2c_f32_bf16 v13, v99, v99
    s_waitcnt lgkmcnt(1)
    v_dot2c_f32_bf16 v10, v100, v60
    v_dot2c_f32_bf16 v12, v100, v100
    v_dot2c_f32_bf16 v11, v101, v60
    v_dot2c_f32_bf16 v13, v101, v101
    v_dot2c_f32_bf16 v10, v102, v60
    v_dot2c_f32_bf16 v12, v102, v102
    v_dot2c_f32_bf16 v11, v103, v60
    v_dot2c_f32_bf16 v13, v103, v103
    s_waitcnt lgkmcnt(0)
    v_dot2c_f32_bf16 v10, v104, v60
    v_dot2c_f32_bf16 v12, v104, v104
    v_dot2c_f32_bf16 v11, v105, v60
    v_dot2c_f32_bf16 v13, v105, v105
    v_dot2c_f32_bf16 v10, v106, v60
    v_dot2c_f32_bf16 v12, v106, v106
    v_dot2c_f32_bf16 v11, v107, v60
    v_dot2c_f32_bf16 v13, v107, v107
    v_and_b32 v6, 15, v1
    v_lshlrev_b32 v6, 3, v6
    v_add_u32 v6, 147456, v6
    v_add_f32 v168, v10, v11
    v_add_f32 v169, v12, v13
    s_waitcnt vmcnt(8)
    s_barrier
    ds_read_b64 v[172:173], v17 offset:0
    ds_read_b64 v[174:175], v17 offset:2048
    ds_read_b64_tr_b16 v[176:177], v22 offset:0
    ds_read_b64_tr_b16 v[178:179], v22 offset:512
    ds_read_b128 v[72:75], v25 offset:0
    ds_read_b128 v[76:79], v25 offset:2048
    ds_read_b64_tr_b16 v[180:181], v22 offset:4096
    ds_read_b64_tr_b16 v[182:183], v22 offset:4608
    ds_read_b128 v[80:83], v26 offset:0
    ds_read_b128 v[84:87], v26 offset:2048
    ds_read_b64_tr_b16 v[184:185], v22 offset:8192
    ds_read_b64_tr_b16 v[186:187], v22 offset:8704
    ds_read_b128 v[88:91], v25 offset:4096
    ds_read_b128 v[92:95], v25 offset:6144
    s_waitcnt lgkmcnt(8)
    v_mfma_f32_16x16x32_bf16 v[120:123], v[176:179], v[72:75], 0
    s_add_u32 m0, s66, 36864
    ds_read_b64_tr_b16 v[188:189], v22 offset:12288
    ds_read_b64_tr_b16 v[190:191], v22 offset:12800
    v_mfma_f32_16x16x32_bf16 v[124:127], v[176:179], v[76:79], 0
    s_mul_i32 s54, s82, 36864
    ds_read_b128 v[96:99], v26 offset:4096
    ds_read_b128 v[100:103], v26 offset:6144
    v_mfma_f32_16x16x32_bf16 v[156:159], v[176:179], v[60:63], 0
    buffer_load_dwordx4 v20, s[16:19], s54 offen lds
    s_add_u32 m0, m0, 4096
    s_waitcnt lgkmcnt(8)
    v_mfma_f32_16x16x32_bf16 v[120:123], v[180:183], v[80:83], v[120:123]
    s_add_u32 s54, s54, 36864
    ds_read_b64_tr_b16 v[192:193], v22 offset:16384
    ds_read_b64_tr_b16 v[194:195], v22 offset:16896
    v_mfma_f32_16x16x32_bf16 v[124:127], v[180:183], v[84:87], v[124:127]
    ds_read_b128 v[104:107], v25 offset:8192
    ds_read_b128 v[108:111], v25 offset:10240
    v_mfma_f32_16x16x32_bf16 v[156:159], v[180:183], v[60:63], v[156:159]
    buffer_load_dwordx4 v20, s[16:19], s54 offen lds
    s_add_u32 m0, m0, 4096
    s_waitcnt lgkmcnt(8)
    v_mfma_f32_16x16x32_bf16 v[120:123], v[184:187], v[88:91], v[120:123]
    s_add_u32 s54, s54, 36864
    ds_read_b64_tr_b16 v[196:197], v22 offset:20480
    ds_read_b64_tr_b16 v[198:199], v22 offset:20992
    v_mfma_f32_16x16x32_bf16 v[124:127], v[184:187], v[92:95], v[124:127]
    ds_read_b128 v[112:115], v26 offset:8192
    ds_read_b128 v[116:119], v26 offset:10240
    v_mfma_f32_16x16x32_bf16 v[156:159], v[184:187], v[60:63], v[156:159]
    buffer_load_dwordx4 v20, s[16:19], s54 offen lds
    s_add_u32 m0, m0, 4096
    s_waitcnt lgkmcnt(8)
    v_mfma_f32_16x16x32_bf16 v[120:123], v[188:191], v[96:99], v[120:123]
    s_add_u32 s54, s54, 36864
    ds_read_b64_tr_b16 v[200:201], v22 offset:24576
    ds_read_b64_tr_b16 v[202:203], v22 offset:25088
    v_mfma_f32_16x16x32_bf16 v[124:127], v[188:191], v[100:103], v[124:127]
    ds_read_b128 v[72:75], v25 offset:12288
    ds_read_b128 v[76:79], v25 offset:14336
    v_mfma_f32_16x16x32_bf16 v[156:159], v[188:191], v[60:63], v[156:159]
    buffer_load_dwordx4 v20, s[16:19], s54 offen lds
    s_add_u32 m0, m0, 4096
    s_waitcnt lgkmcnt(8)
    v_mfma_f32_16x16x32_bf16 v[120:123], v[192:195], v[104:107], v[120:123]
    s_add_u32 s54, s54, 36864
    ds_read_b64_tr_b16 v[204:205], v22 offset:28672
    ds_read_b64_tr_b16 v[206:207], v22 offset:29184
    v_mfma_f32_16x16x32_bf16 v[124:127], v[192:195], v[108:111], v[124:127]
    ds_read_b128 v[80:83], v26 offset:12288
    ds_read_b128 v[84:87], v26 offset:14336
    v_mfma_f32_16x16x32_bf16 v[156:159], v[192:195], v[60:63], v[156:159]
    buffer_load_dwordx4 v20, s[16:19], s54 offen lds
    s_add_u32 m0, m0, 4096
    s_waitcnt lgkmcnt(8)
    v_mfma_f32_16x16x32_bf16 v[120:123], v[196:199], v[112:115], v[120:123]
    s_add_u32 s54, s54, 36864
    ds_read_b64_tr_b16 v[208:209], v22 offset:32768
    ds_read_b64_tr_b16 v[210:211], v22 offset:33280
    v_mfma_f32_16x16x32_bf16 v[124:127], v[196:199], v[116:119], v[124:127]
    ds_read_b128 v[88:91], v25 offset:16384
    ds_read_b128 v[92:95], v25 offset:18432
    v_mfma_f32_16x16x32_bf16 v[156:159], v[196:199], v[60:63], v[156:159]
    buffer_load_dwordx4 v20, s[16:19], s54 offen lds
    s_add_u32 m0, m0, 4096
    s_waitcnt lgkmcnt(8)
    v_mfma_f32_16x16x32_bf16 v[120:123], v[200:203], v[72:75], v[120:123]
    s_add_u32 s54, s54, 36864
    ds_read_b64_tr_b16 v[212:213], v23 offset:0
    ds_read_b64_tr_b16 v[214:215], v23 offset:512
    v_mfma_f32_16x16x32_bf16 v[124:127], v[200:203], v[76:79], v[124:127]
    ds_read_b128 v[96:99], v26 offset:16384
    ds_read_b128 v[100:103], v26 offset:18432
    v_mfma_f32_16x16x32_bf16 v[156:159], v[200:203], v[60:63], v[156:159]
    buffer_load_dwordx4 v20, s[16:19], s54 offen lds
    s_add_u32 m0, m0, 4096
    s_waitcnt lgkmcnt(8)
    v_mfma_f32_16x16x32_bf16 v[120:123], v[204:207], v[80:83], v[120:123]
    s_add_u32 s54, s54, 36864
    s_waitcnt vmcnt(7)
    s_barrier
    ds_read_b64_tr_b16 v[216:217], v23 offset:4096
    ds_read_b64_tr_b16 v[218:219], v23 offset:4608
    v_mfma_f32_16x16x32_bf16 v[124:127], v[204:207], v[84:87], v[124:127]
    ds_read_b128 v[104:107], v25 offset:20480
    ds_read_b128 v[108:111], v25 offset:22528
    v_mfma_f32_16x16x32_bf16 v[156:159], v[204:207], v[60:63], v[156:159]
    buffer_load_dwordx4 v20, s[16:19], s54 offen lds
    s_add_u32 m0, m0, 4096
    s_waitcnt lgkmcnt(8)
    v_mfma_f32_16x16x32_bf16 v[120:123], v[208:211], v[88:91], v[120:123]
    s_add_u32 s54, s54, 36864
    ds_read_b64_tr_b16 v[220:221], v23 offset:8192
    ds_read_b64_tr_b16 v[222:223], v23 offset:8704
    v_mfma_f32_16x16x32_bf16 v[124:127], v[208:211], v[92:95], v[124:127]
    ds_read_b128 v[112:115], v26 offset:20480
    ds_read_b128 v[116:119], v26 offset:22528
    v_mfma_f32_16x16x32_bf16 v[156:159], v[208:211], v[60:63], v[156:159]
    buffer_load_dwordx4 v20, s[16:19], s54 offen lds
    v_add_f32_dpp v168, v168, v168 quad_perm:[1,0,3,2] row_mask:0xf bank_mask:0xf
    s_waitcnt lgkmcnt(8)
    v_mfma_f32_16x16x32_bf16 v[120:123], v[212:215], v[96:99], v[120:123]
    ds_read_b64_tr_b16 v[224:225], v23 offset:12288
    ds_read_b64_tr_b16 v[226:227], v23 offset:12800
    v_mfma_f32_16x16x32_bf16 v[124:127], v[212:215], v[100:103], v[124:127]
    ds_read_b128 v[72:75], v25 offset:24576
    ds_read_b128 v[76:79], v25 offset:26624
    v_mfma_f32_16x16x32_bf16 v[156:159], v[212:215], v[60:63], v[156:159]
    v_add_f32_dpp v169, v169, v169 quad_perm:[1,0,3,2] row_mask:0xf bank_mask:0xf
    v_add_f32_dpp v168, v168, v168 quad_perm:[2,3,0,1] row_mask:0xf bank_mask:0xf
    s_waitcnt lgkmcnt(8)
    v_mfma_f32_16x16x32_bf16 v[120:123], v[216:219], v[104:107], v[120:123]
    ds_read_b64_tr_b16 v[228:229], v23 offset:16384
    ds_read_b64_tr_b16 v[230:231], v23 offset:16896
    v_mfma_f32_16x16x32_bf16 v[124:127], v[216:219], v[108:111], v[124:127]
    ds_read_b128 v[80:83], v26 offset:24576
    ds_read_b128 v[84:87], v26 offset:26624
    v_mfma_f32_16x16x32_bf16 v[156:159], v[216:219], v[60:63], v[156:159]
    v_add_f32_dpp v169, v169, v169 quad_perm:[2,3,0,1] row_mask:0xf bank_mask:0xf
    v_add_f32_dpp v168, v168, v168 row_half_mirror row_mask:0xf bank_mask:0xf
    s_waitcnt lgkmcnt(8)
    v_mfma_f32_16x16x32_bf16 v[120:123], v[220:223], v[112:115], v[120:123]
    ds_read_b64_tr_b16 v[232:233], v23 offset:20480
    ds_read_b64_tr_b16 v[234:235], v23 offset:20992
    v_mfma_f32_16x16x32_bf16 v[124:127], v[220:223], v[116:119], v[124:127]
    ds_read_b128 v[88:91], v25 offset:28672
    ds_read_b128 v[92:95], v25 offset:30720
    v_mfma_f32_16x16x32_bf16 v[156:159], v[220:223], v[60:63], v[156:159]
    v_add_f32_dpp v169, v169, v169 row_half_mirror row_mask:0xf bank_mask:0xf
    v_mul_f32 v168, 0x3ae38e39, v168
    s_waitcnt lgkmcnt(8)
    v_mfma_f32_16x16x32_bf16 v[120:123], v[224:227], v[72:75], v[120:123]
    ds_read_b64_tr_b16 v[236:237], v23 offset:24576
    ds_read_b64_tr_b16 v[238:239], v23 offset:25088
    v_mfma_f32_16x16x32_bf16 v[124:127], v[224:227], v[76:79], v[124:127]
    ds_read_b128 v[96:99], v26 offset:28672
    ds_read_b128 v[100:103], v26 offset:30720
    v_mfma_f32_16x16x32_bf16 v[156:159], v[224:227], v[60:63], v[156:159]
    v_mul_f32 v169, 0x3ae38e39, v169
    v_fma_f32 v169, -v168, v168, v169
    s_waitcnt lgkmcnt(8)
    v_mfma_f32_16x16x32_bf16 v[120:123], v[228:231], v[80:83], v[120:123]
    ds_read_b64_tr_b16 v[240:241], v23 offset:28672
    ds_read_b64_tr_b16 v[242:243], v23 offset:29184
    v_mfma_f32_16x16x32_bf16 v[124:127], v[228:231], v[84:87], v[124:127]
    ds_read_b128 v[104:107], v25 offset:32768
    ds_read_b128 v[108:111], v25 offset:34816
    v_mfma_f32_16x16x32_bf16 v[156:159], v[228:231], v[60:63], v[156:159]
    v_max_f32 v169, 0, v169
    v_cvt_pk_bf16_f32 v12, v168, v169
    s_waitcnt lgkmcnt(8)
    v_mfma_f32_16x16x32_bf16 v[120:123], v[232:235], v[88:91], v[120:123]
    ds_read_b64_tr_b16 v[244:245], v23 offset:32768
    ds_read_b64_tr_b16 v[246:247], v23 offset:33280
    v_mfma_f32_16x16x32_bf16 v[124:127], v[232:235], v[92:95], v[124:127]
    ds_read_b128 v[112:115], v26 offset:32768
    ds_read_b128 v[116:119], v26 offset:34816
    v_mfma_f32_16x16x32_bf16 v[156:159], v[232:235], v[60:63], v[156:159]
    v_lshlrev_b32 v168, 16, v12
    v_and_b32 v169, 0xffff0000, v12
    s_waitcnt lgkmcnt(8)
    v_mfma_f32_16x16x32_bf16 v[120:123], v[236:239], v[96:99], v[120:123]
    v_add_f32 v169, 0x3727c5ac, v169
    v_cvt_pk_bf16_f32 v12, v169, v169
    v_mfma_f32_16x16x32_bf16 v[124:127], v[236:239], v[100:103], v[124:127]
    v_lshlrev_b32 v169, 16, v12
    v_sqrt_f32 v169, v169
    v_mfma_f32_16x16x32_bf16 v[156:159], v[236:239], v[60:63], v[156:159]
    v_cvt_pk_bf16_f32 v12, v169, v169
    v_lshlrev_b32 v169, 16, v12
    s_waitcnt lgkmcnt(4)
    v_mfma_f32_16x16x32_bf16 v[120:123], v[240:243], v[104:107], v[120:123]
    v_rcp_f32 v12, v169
    s_nop 0
    v_mul_f32 v169, -v168, v12
    v_mfma_f32_16x16x32_bf16 v[124:127], v[240:243], v[108:111], v[124:127]
    v_mov_b32 v168, v12
    v_readfirstlane_b32 s48, v18
    v_mfma_f32_16x16x32_bf16 v[156:159], v[240:243], v[60:63], v[156:159]
    v_readfirstlane_b32 s49, v19
    s_add_u32 s48, s48, 1
    s_waitcnt lgkmcnt(0)
    v_mfma_f32_16x16x32_bf16 v[120:123], v[244:247], v[112:115], v[120:123]
    s_add_u32 s49, s49, 1
    v_mfma_f32_16x16x32_bf16 v[124:127], v[244:247], v[116:119], v[124:127]
    v_mfma_f32_16x16x32_bf16 v[156:159], v[244:247], v[60:63], v[156:159]
    ds_write_b64 v14, v[168:169]
    s_waitcnt lgkmcnt(0)
    s_barrier
    ds_read_b64 v[168:169], v6
    ds_read_b64 v[170:171], v6 offset:128
    s_waitcnt lgkmcnt(0)
    v_pk_mul_f32 v[120:121], v[120:121], v[168:169] op_sel_hi:[1,0]
    v_pk_mul_f32 v[122:123], v[122:123], v[168:169] op_sel_hi:[1,0]
    v_pk_fma_f32 v[120:121], v[156:157], v[168:169], v[120:121] op_sel:[0,1,0]
    v_pk_fma_f32 v[122:123], v[158:159], v[168:169], v[122:123] op_sel:[0,1,0]
    v_pk_mul_f32 v[124:125], v[124:125], v[170:171] op_sel_hi:[1,0]
    v_pk_mul_f32 v[126:127], v[126:127], v[170:171] op_sel_hi:[1,0]
    v_pk_fma_f32 v[124:125], v[156:157], v[170:171], v[124:125] op_sel:[0,1,0]
    v_pk_fma_f32 v[126:127], v[158:159], v[170:171], v[126:127] op_sel:[0,1,0]
    v_pk_mul_f32 v[72:73], v[120:121], v[120:121]
    v_pk_mul_f32 v[74:75], v[122:123], v[122:123]
    v_pk_mul_f32 v[76:77], v[124:125], v[124:125]
    v_pk_mul_f32 v[78:79], v[126:127], v[126:127]
    v_pk_fma_f32 v[72:73], v[72:73], s[72:73], v[4:5]
    v_pk_fma_f32 v[74:75], v[74:75], s[72:73], v[4:5]
    v_pk_fma_f32 v[76:77], v[76:77], s[72:73], v[4:5]
    v_pk_fma_f32 v[78:79], v[78:79], s[72:73], v[4:5]
    v_pk_mul_f32 v[72:73], v[72:73], v[120:121]
    v_pk_mul_f32 v[74:75], v[74:75], v[122:123]
    v_pk_mul_f32 v[76:77], v[76:77], v[124:125]
    v_pk_mul_f32 v[78:79], v[78:79], v[126:127]
    v_exp_f32 v72, v72
    v_exp_f32 v73, v73
    v_exp_f32 v74, v74
    v_exp_f32 v75, v75
    v_exp_f32 v76, v76
    v_exp_f32 v77, v77
    v_exp_f32 v78, v78
    v_exp_f32 v79, v79
    v_pk_add_f32 v[72:73], v[72:73], 1.0 op_sel_hi:[1,0]
    v_pk_add_f32 v[74:75], v[74:75], 1.0 op_sel_hi:[1,0]
    v_pk_add_f32 v[76:77], v[76:77], 1.0 op_sel_hi:[1,0]
    v_pk_add_f32 v[78:79], v[78:79], 1.0 op_sel_hi:[1,0]
    v_rcp_f32 v72, v72
    v_rcp_f32 v73, v73
    v_rcp_f32 v74, v74
    v_rcp_f32 v75, v75
    v_rcp_f32 v76, v76
    v_rcp_f32 v77, v77
    v_rcp_f32 v78, v78
    v_rcp_f32 v79, v79
    v_pk_mul_f32 v[120:121], v[120:121], v[72:73]
    v_pk_mul_f32 v[122:123], v[122:123], v[74:75]
    v_pk_mul_f32 v[124:125], v[124:125], v[76:77]
    v_pk_mul_f32 v[126:127], v[126:127], v[78:79]
    v_cvt_pk_bf16_f32 v80, v120, v121
    v_cvt_pk_bf16_f32 v81, v122, v123
    v_cvt_pk_bf16_f32 v82, v124, v125
    v_cvt_pk_bf16_f32 v83, v126, v127
    s_nop 0
    v_permlane16_swap_b32 v80, v82
    v_permlane16_swap_b32 v81, v83
    v_cndmask_b32 v80, 0, v80, s[76:77]
    v_cndmask_b32 v81, 0, v81, s[76:77]
    v_cndmask_b32 v82, 0, v82, s[76:77]
    v_cndmask_b32 v83, 0, v83, s[76:77]
    buffer_store_dwordx4 v[80:83], v15, s[36:39], s78 offen
    s_add_u32 m0, s66, 73728
    s_mul_i32 s54, s83, 36864
    buffer_load_dwordx4 v20, s[16:19], s54 offen lds
    s_add_u32 m0, m0, 4096
    s_add_u32 s54, s54, 36864
    buffer_load_dwordx4 v20, s[16:19], s54 offen lds
    s_add_u32 m0, m0, 4096
    s_add_u32 s54, s54, 36864
    buffer_load_dwordx4 v20, s[16:19], s54 offen lds
    s_add_u32 m0, m0, 4096
    s_add_u32 s54, s54, 36864
    buffer_load_dwordx4 v20, s[16:19], s54 offen lds
    s_add_u32 m0, m0, 4096
    s_add_u32 s54, s54, 36864
    buffer_load_dwordx4 v20, s[16:19], s54 offen lds
    s_mul_i32 s52, s45, 72
    s_add_u32 s52, s52, s40
    s_lshl_b32 s58, s40, 15
    s_mul_i32 s51, s45, 1152
    s_add_u32 s58, s58, s51
    s_add_u32 s58, s58, 4224
    s_add_u32 s59, s69, 262144
    v_add_u32 v14, 36864, v2
    s_or_b32 s50, s47, 16
    v_mov_b32 v6, s50
    v_mov_b32 v7, s57
    s_waitcnt vmcnt(5)
    s_barrier
    s_mov_b64 exec, s[74:75]
    buffer_store_byte v6, v7, s[32:35], 0 offen
    s_mov_b64 exec, -1
    s_add_u32 m0, m0, 4096
    s_add_u32 s54, s54, 36864
    buffer_load_dwordx4 v20, s[16:19], s54 offen lds
    s_add_u32 m0, m0, 4096
    s_add_u32 s54, s54, 36864
    buffer_load_dwordx4 v20, s[16:19], s54 offen lds
    s_add_u32 m0, m0, 4096
    s_add_u32 s54, s54, 36864
    buffer_load_dwordx4 v20, s[16:19], s54 offen lds
    s_add_u32 m0, m0, 4096
    s_add_u32 s54, s54, 36864
    buffer_load_dwordx4 v20, s[16:19], s54 offen lds
    ds_read_b64_tr_b16 v[176:177], v21 offset:0
    ds_read_b64_tr_b16 v[178:179], v21 offset:512
    ds_read_b64_tr_b16 v[180:181], v21 offset:4096
    ds_read_b64_tr_b16 v[182:183], v21 offset:4608
    ds_read_b64_tr_b16 v[184:185], v21 offset:8192
    ds_read_b64_tr_b16 v[186:187], v21 offset:8704
    ds_read_b64_tr_b16 v[188:189], v21 offset:12288
    ds_read_b64_tr_b16 v[190:191], v21 offset:12800
    ds_read_b64_tr_b16 v[192:193], v21 offset:16384
    ds_read_b64_tr_b16 v[194:195], v21 offset:16896
    ds_read_b64_tr_b16 v[196:197], v21 offset:20480
    ds_read_b64_tr_b16 v[198:199], v21 offset:20992
    ds_read_b64_tr_b16 v[200:201], v21 offset:24576
    ds_read_b64_tr_b16 v[202:203], v21 offset:25088
    ds_read_b64_tr_b16 v[204:205], v21 offset:28672
    ds_read_b64_tr_b16 v[206:207], v21 offset:29184
    ds_read_b64_tr_b16 v[208:209], v21 offset:32768
    ds_read_b64_tr_b16 v[210:211], v21 offset:33280
    s_waitcnt vmcnt(0)
    s_waitcnt lgkmcnt(0)
    s_cmp_lg_u32 s44, 0
    s_cbranch_scc1 wl_done_1
    v_min_u32 v7, 8, v1
    v_lshl_add_u32 v6, v7, 3, s52
    s_or_b32 s50, s47, 16
    s_mov_b32 s55, 0
wl_fast_2:
    s_cmp_ge_u32 s55, 64
    s_cbranch_scc1 wl_slow_3
    buffer_load_ubyte v8, v6, s[32:35], 0 offen sc1
    s_add_u32 s55, s55, 1
    s_waitcnt vmcnt(0)
    v_and_b32 v9, 23, v8
    v_cmp_ne_u32 vcc, s50, v9
    s_nop 4
    s_cbranch_vccnz wl_fast_2
wl_done_1:
    s_barrier
    s_add_u32 m0, s66, 36864
    s_add_u32 s54, s66, s59
    buffer_load_dwordx4 v2, s[36:39], s54 offen sc1 lds
    s_add_u32 m0, m0, 4096
    s_add_u32 s54, s54, 4096
    buffer_load_dwordx4 v2, s[36:39], s54 offen sc1 lds
    s_add_u32 m0, m0, 4096
    s_add_u32 s54, s54, 4096
    buffer_load_dwordx4 v2, s[36:39], s54 offen sc1 lds
    s_add_u32 m0, m0, 4096
    s_add_u32 s54, s54, 4096
    buffer_load_dwordx4 v2, s[36:39], s54 offen sc1 lds
    s_add_u32 m0, m0, 4096
    s_add_u32 s54, s54, 4096
    buffer_load_dwordx4 v2, s[36:39], s54 offen sc1 lds
    s_add_u32 m0, m0, 4096
    s_add_u32 s54, s54, 4096
    buffer_load_dwordx4 v2, s[36:39], s54 offen sc1 lds
    s_add_u32 m0, m0, 4096
    s_add_u32 s54, s54, 4096
    buffer_load_dwordx4 v2, s[36:39], s54 offen sc1 lds
    s_add_u32 m0, m0, 4096
    s_add_u32 s54, s54, 4096
    buffer_load_dwordx4 v2, s[36:39], s54 offen sc1 lds
    s_add_u32 m0, m0, 4096
    s_add_u32 s54, s54, 4096
    buffer_load_dwordx4 v2, s[36:39], s54 offen sc1 lds
    s_lshl_b32 s58, s40, 15
    s_lshl_b32 s50, s41, 9
    s_add_u32 s58, s58, s50
    s_add_u32 s58, s58, 16384
    v_and_b32 v15, 31, v1
    v_lshlrev_b32 v15, 3, v15
    v_add_u32 v15, 147968, v15
    s_lshl_b32 s50, s44, 8
    v_add_u32 v17, s50, v15
    ds_read_b64_tr_b16 v[212:213], v22 offset:0
    ds_read_b64_tr_b16 v[214:215], v22 offset:512
    ds_read_b64_tr_b16 v[216:217], v22 offset:4096
    ds_read_b64_tr_b16 v[218:219], v22 offset:4608
    ds_read_b64_tr_b16 v[220:221], v22 offset:8192
    ds_read_b64_tr_b16 v[222:223], v22 offset:8704
    ds_read_b64_tr_b16 v[224:225], v22 offset:12288
    ds_read_b64_tr_b16 v[226:227], v22 offset:12800
    ds_read_b64_tr_b16 v[228:229], v22 offset:16384
    ds_read_b64_tr_b16 v[230:231], v22 offset:16896
    ds_read_b64_tr_b16 v[232:233], v22 offset:20480
    ds_read_b64_tr_b16 v[234:235], v22 offset:20992
    ds_read_b64_tr_b16 v[236:237], v22 offset:24576
    ds_read_b64_tr_b16 v[238:239], v22 offset:25088
    ds_read_b64_tr_b16 v[240:241], v22 offset:28672
    ds_read_b64_tr_b16 v[242:243], v22 offset:29184
    ds_read_b64_tr_b16 v[244:245], v22 offset:32768
    ds_read_b64_tr_b16 v[246:247], v22 offset:33280
    s_waitcnt lgkmcnt(0)
    s_waitcnt vmcnt(5)
    s_barrier
    ds_read_b128 v[72:75], v14 offset:0
    ds_read_b128 v[76:79], v14 offset:1024
    ds_read_b128 v[80:83], v14 offset:2048
    ds_read_b128 v[84:87], v14 offset:3072
    ds_read_b128 v[88:91], v14 offset:4096
    ds_read_b128 v[92:95], v14 offset:5120
    s_waitcnt lgkmcnt(4)
    v_mfma_f32_16x16x32_bf16 v[120:123], v[176:179], v[72:75], 0
    s_add_u32 m0, s67, 110592
    ds_read_b128 v[96:99], v14 offset:6144
    s_add_u32 s54, s70, 0
    v_mfma_f32_16x16x32_bf16 v[124:127], v[176:179], v[76:79], 0
    s_mov_b32 exec_hi, 0
    buffer_load_dwordx4 v27, s[20:23], s54 offen lds
    s_mov_b32 exec_hi, -1
    ds_read_b128 v[100:103], v14 offset:7168
    s_waitcnt lgkmcnt(4)
    v_mfma_f32_16x16x32_bf16 v[120:123], v[180:183], v[80:83], v[120:123]
    ds_read_b128 v[104:107], v14 offset:8192
    v_mfma_f32_16x16x32_bf16 v[124:127], v[180:183], v[84:87], v[124:127]
    ds_read_b128 v[108:111], v14 offset:9216
    s_waitcnt lgkmcnt(4)
    v_mfma_f32_16x16x32_bf16 v[120:123], v[184:187], v[88:91], v[120:123]
    ds_read_b128 v[112:115], v14 offset:10240
    buffer_load_dwordx4 v28, s[20:23], s54 offen offset:512 lds
    v_mfma_f32_16x16x32_bf16 v[124:127], v[184:187], v[92:95], v[124:127]
    ds_read_b128 v[116:119], v14 offset:11264
    s_waitcnt lgkmcnt(4)
    v_mfma_f32_16x16x32_bf16 v[120:123], v[188:191], v[96:99], v[120:123]
    ds_read_b128 v[72:75], v14 offset:12288
    v_mfma_f32_16x16x32_bf16 v[124:127], v[188:191], v[100:103], v[124:127]
    ds_read_b128 v[76:79], v14 offset:13312
    s_waitcnt lgkmcnt(4)
    v_mfma_f32_16x16x32_bf16 v[120:123], v[192:195], v[104:107], v[120:123]
    ds_read_b128 v[80:83], v14 offset:14336
    buffer_load_dwordx4 v29, s[20:23], s54 offen offset:1536 lds
    v_mfma_f32_16x16x32_bf16 v[124:127], v[192:195], v[108:111], v[124:127]
    ds_read_b128 v[84:87], v14 offset:15360
    s_waitcnt lgkmcnt(4)
    v_mfma_f32_16x16x32_bf16 v[120:123], v[196:199], v[112:115], v[120:123]
    s_waitcnt vmcnt(3)
    s_barrier
    ds_read_b128 v[88:91], v14 offset:16384
    v_mfma_f32_16x16x32_bf16 v[124:127], v[196:199], v[116:119], v[124:127]
    ds_read_b128 v[92:95], v14 offset:17408
    s_waitcnt lgkmcnt(4)
    v_mfma_f32_16x16x32_bf16 v[120:123], v[200:203], v[72:75], v[120:123]
    ds_read_b128 v[96:99], v14 offset:18432
    buffer_load_dwordx4 v30, s[20:23], s54 offen offset:2560 lds
    v_mfma_f32_16x16x32_bf16 v[124:127], v[200:203], v[76:79], v[124:127]
    ds_read_b128 v[100:103], v14 offset:19456
    s_waitcnt lgkmcnt(4)
    v_mfma_f32_16x16x32_bf16 v[120:123], v[204:207], v[80:83], v[120:123]
    ds_read_b128 v[104:107], v14 offset:20480
    v_mfma_f32_16x16x32_bf16 v[124:127], v[204:207], v[84:87], v[124:127]
    ds_read_b128 v[108:111], v14 offset:21504
    s_waitcnt lgkmcnt(4)
    v_mfma_f32_16x16x32_bf16 v[120:123], v[208:211], v[88:91], v[120:123]
    ds_read_b128 v[112:115], v14 offset:22528
    buffer_load_dwordx4 v31, s[20:23], s54 offen offset:3584 lds
    v_mfma_f32_16x16x32_bf16 v[124:127], v[208:211], v[92:95], v[124:127]
    s_add_u32 m0, s67, 129024
    ds_read_b128 v[116:119], v14 offset:23552
    s_waitcnt lgkmcnt(4)
    v_mfma_f32_16x16x32_bf16 v[120:123], v[212:215], v[96:99], v[120:123]
    s_add_u32 s54, s70, 589824
    ds_read_b128 v[72:75], v14 offset:24576
    v_mfma_f32_16x16x32_bf16 v[124:127], v[212:215], v[100:103], v[124:127]
    s_mov_b32 exec_hi, 0
    buffer_load_dwordx4 v27, s[20:23], s54 offen lds
    s_mov_b32 exec_hi, -1
    ds_read_b128 v[76:79], v14 offset:25600
    s_waitcnt lgkmcnt(4)
    v_mfma_f32_16x16x32_bf16 v[120:123], v[216:219], v[104:107], v[120:123]
    ds_read_b128 v[80:83], v14 offset:26624
    v_mfma_f32_16x16x32_bf16 v[124:127], v[216:219], v[108:111], v[124:127]
    ds_read_b128 v[84:87], v14 offset:27648
    s_waitcnt lgkmcnt(4)
    v_mfma_f32_16x16x32_bf16 v[120:123], v[220:223], v[112:115], v[120:123]
    ds_read_b128 v[88:91], v14 offset:28672
    buffer_load_dwordx4 v28, s[20:23], s54 offen offset:512 lds
    v_mfma_f32_16x16x32_bf16 v[124:127], v[220:223], v[116:119], v[124:127]
    ds_read_b128 v[92:95], v14 offset:29696
    s_waitcnt lgkmcnt(4)
    v_mfma_f32_16x16x32_bf16 v[120:123], v[224:227], v[72:75], v[120:123]
    ds_read_b128 v[96:99], v14 offset:30720
    v_mfma_f32_16x16x32_bf16 v[124:127], v[224:227], v[76:79], v[124:127]
    ds_read_b128 v[100:103], v14 offset:31744
    s_waitcnt lgkmcnt(4)
    v_mfma_f32_16x16x32_bf16 v[120:123], v[228:231], v[80:83], v[120:123]
    ds_read_b128 v[104:107], v14 offset:32768
    buffer_load_dwordx4 v29, s[20:23], s54 offen offset:1536 lds
    v_mfma_f32_16x16x32_bf16 v[124:127], v[228:231], v[84:87], v[124:127]
    ds_read_b128 v[108:111], v14 offset:33792
    s_waitcnt lgkmcnt(4)
    v_mfma_f32_16x16x32_bf16 v[120:123], v[232:235], v[88:91], v[120:123]
    ds_read_b128 v[112:115], v14 offset:34816
    v_mfma_f32_16x16x32_bf16 v[124:127], v[232:235], v[92:95], v[124:127]
    ds_read_b128 v[116:119], v14 offset:35840
    s_waitcnt lgkmcnt(4)
    v_mfma_f32_16x16x32_bf16 v[120:123], v[236:239], v[96:99], v[120:123]
    buffer_load_dwordx4 v30, s[20:23], s54 offen offset:2560 lds
    v_mfma_f32_16x16x32_bf16 v[124:127], v[236:239], v[100:103], v[124:127]
    s_waitcnt lgkmcnt(2)
    v_mfma_f32_16x16x32_bf16 v[120:123], v[240:243], v[104:107], v[120:123]
    v_mfma_f32_16x16x32_bf16 v[124:127], v[240:243], v[108:111], v[124:127]
    buffer_load_dwordx4 v31, s[20:23], s54 offen offset:3584 lds
    s_waitcnt lgkmcnt(0)
    v_mfma_f32_16x16x32_bf16 v[120:123], v[244:247], v[112:115], v[120:123]
    v_mfma_f32_16x16x32_bf16 v[124:127], v[244:247], v[116:119], v[124:127]
    s_nop 6
    v_cvt_pk_bf16_f32 v80, v120, v121
    v_lshlrev_b32 v88, 16, v172
    v_and_b32 v89, 0xffff0000, v172
    v_lshlrev_b32 v90, 16, v80
    v_and_b32 v91, 0xffff0000, v80
    v_pk_add_f32 v[88:89], v[88:89], v[90:91]
    v_cvt_pk_bf16_f32 v80, v88, v89
    v_cvt_pk_bf16_f32 v81, v122, v123
    v_lshlrev_b32 v92, 16, v173
    v_and_b32 v93, 0xffff0000, v173
    v_lshlrev_b32 v94, 16, v81
    v_and_b32 v95, 0xffff0000, v81
    v_pk_add_f32 v[92:93], v[92:93], v[94:95]
    v_cvt_pk_bf16_f32 v81, v92, v93
    v_cvt_pk_bf16_f32 v82, v124, v125
    v_lshlrev_b32 v96, 16, v174
    v_and_b32 v97, 0xffff0000, v174
    v_lshlrev_b32 v98, 16, v82
    v_and_b32 v99, 0xffff0000, v82
    v_pk_add_f32 v[96:97], v[96:97], v[98:99]
    v_cvt_pk_bf16_f32 v82, v96, v97
    v_cvt_pk_bf16_f32 v83, v126, v127
    v_lshlrev_b32 v100, 16, v175
    v_and_b32 v101, 0xffff0000, v175
    v_lshlrev_b32 v102, 16, v83
    v_and_b32 v103, 0xffff0000, v83
    v_pk_add_f32 v[100:101], v[100:101], v[102:103]
    v_cvt_pk_bf16_f32 v83, v100, v101
    v_permlane16_swap_b32 v80, v82
    s_nop 0
    v_permlane16_swap_b32 v81, v83
    buffer_store_dwordx4 v[80:83], v16, s[36:39], s79 offen sc1
    v_mov_b32 v168, 0
    v_mov_b32 v169, 0
    v_mov_b32 v170, 0
    v_mov_b32 v171, 0
    v_dot2c_f32_bf16 v168, v80, v60
    v_dot2c_f32_bf16 v169, v80, v80
    v_dot2c_f32_bf16 v168, v81, v60
    v_dot2c_f32_bf16 v169, v81, v81
    v_dot2c_f32_bf16 v168, v82, v60
    v_dot2c_f32_bf16 v169, v82, v82
    v_dot2c_f32_bf16 v168, v83, v60
    v_dot2c_f32_bf16 v169, v83, v83
    s_nop 1
    v_permlane32_swap_b32 v168, v170
    v_permlane32_swap_b32 v169, v171
    v_pk_add_f32 v[168:169], v[168:169], v[170:171]
    s_mov_b32 exec_hi, 0
    ds_write_b64 v17, v[168:169]
    s_mov_b32 exec_hi, -1
    s_add_u32 m0, s67, 0
    s_add_u32 s54, s70, 1179648
    s_mov_b32 exec_hi, 0
    buffer_load_dwordx4 v27, s[20:23], s54 offen lds
    s_mov_b32 exec_hi, -1
    buffer_load_dwordx4 v28, s[20:23], s54 offen offset:512 lds
    buffer_load_dwordx4 v29, s[20:23], s54 offen offset:1536 lds
    buffer_load_dwordx4 v30, s[20:23], s54 offen offset:2560 lds
    buffer_load_dwordx4 v31, s[20:23], s54 offen offset:3584 lds
    s_add_u32 m0, s67, 18432
    s_add_u32 s54, s70, 1769472
    s_mov_b32 exec_hi, 0
    buffer_load_dwordx4 v27, s[20:23], s54 offen lds
    s_mov_b32 exec_hi, -1
    buffer_load_dwordx4 v28, s[20:23], s54 offen offset:512 lds
    buffer_load_dwordx4 v29, s[20:23], s54 offen offset:1536 lds
    s_waitcnt lgkmcnt(0)
    s_waitcnt vmcnt(8)
    s_barrier
    s_cmp_lg_u32 s44, 0
    s_cbranch_scc1 f2_4
    ds_read_b64 v[72:73], v15 offset:0
    ds_read_b64 v[74:75], v15 offset:256
    ds_read_b64 v[76:77], v15 offset:512
    ds_read_b64 v[78:79], v15 offset:768
    v_mov_b32 v168, s49
    v_mov_b32 v171, s49
    s_waitcnt lgkmcnt(0)
    v_pk_add_f32 v[72:73], v[72:73], v[74:75]
    v_pk_add_f32 v[76:77], v[76:77], v[78:79]
    v_add_f32 v169, v72, v76
    v_add_f32 v170, v73, v77
    s_mov_b32 exec_hi, 0
    buffer_store_dwordx4 v[168:171], v2, s[36:39], s58 offen sc1
    s_mov_b32 exec_hi, -1
f2_4:
    v_and_b32 v8, 15, v1
    buffer_load_dwordx4 v30, s[20:23], s54 offen offset:2560 lds
    v_lshlrev_b32 v8, 3, v8
    s_add_u32 s50, s44, 0
    s_and_b32 s50, s50, 3
    s_lshl_b32 s51, s50, 10
    v_add_u32 v43, s51, v2
    v_add_u32 v47, 0x10000, v43
    s_lshl_b32 s51, s50, 7
    s_add_u32 s51, s51, 147456
    buffer_load_dwordx4 v31, s[20:23], s54 offen offset:3584 lds
    s_add_u32 m0, s67, 73728
    s_add_u32 s54, s70, 2359296
    v_add_u32 v55, s51, v8
    s_add_u32 s50, s44, 1
    s_and_b32 s50, s50, 3
    s_lshl_b32 s51, s50, 10
    v_add_u32 v44, s51, v2
    v_add_u32 v48, 0x10000, v44
    s_lshl_b32 s51, s50, 7
    s_add_u32 s51, s51, 147456
    s_mov_b32 exec_hi, 0
    buffer_load_dwordx4 v27, s[20:23], s54 offen lds
    s_mov_b32 exec_hi, -1
    v_add_u32 v56, s51, v8
    s_add_u32 s50, s44, 2
    s_and_b32 s50, s50, 3
    s_lshl_b32 s51, s50, 10
    v_add_u32 v45, s51, v2
    v_add_u32 v49, 0x10000, v45
    s_lshl_b32 s51, s50, 7
    s_add_u32 s51, s51, 147456
    buffer_load_dwordx4 v28, s[20:23], s54 offen offset:512 lds
    v_add_u32 v57, s51, v8
    s_add_u32 s50, s44, 3
    s_and_b32 s50, s50, 3
    s_lshl_b32 s51, s50, 10
    v_add_u32 v46, s51, v2
    v_add_u32 v50, 0x10000, v46
    s_lshl_b32 s51, s50, 7
    s_add_u32 s51, s51, 147456
    buffer_load_dwordx4 v29, s[20:23], s54 offen offset:1536 lds
    v_add_u32 v58, s51, v8
    s_lshl_b32 s68, s40, 3
    s_add_u32 s68, s68, s42
    s_mul_i32 s68, s68, 73728
    s_add_u32 s68, s68, 2097152
    s_mul_i32 s50, s43, 144
    s_lshl_b32 s51, s44, 5
    s_add_u32 s51, s51, s50
    buffer_load_dwordx4 v30, s[20:23], s54 offen offset:2560 lds
    s_add_u32 s50, s50, 128
    s_lshr_b32 s52, s40, 1
    s_lshl_b32 s52, s52, 10
    s_and_b32 s53, s40, 1
    s_lshl_b32 s53, s53, 7
    s_add_u32 s52, s52, s53
    v_and_b32 v9, 7, v1
    v_lshrrev_b32 v6, 3, v1
    buffer_load_dwordx4 v31, s[20:23], s54 offen offset:3584 lds
    s_add_u32 m0, s67, 92160
    s_add_u32 s54, s70, 2949120
    v_lshl_add_u32 v6, v6, 2, s51
    v_mul_u32_u24 v7, 1152, v9
    v_lshl_add_u32 v53, v6, 1, v7
    v_lshrrev_b32 v7, 5, v6
    v_lshlrev_b32 v7, 12, v7
    v_bfe_u32 v8, v6, 3, 2
    v_lshl_add_u32 v7, v8, 8, v7
    v_and_b32 v8, 7, v6
    s_mov_b32 exec_hi, 0
    buffer_load_dwordx4 v27, s[20:23], s54 offen lds
    s_mov_b32 exec_hi, -1
    v_lshl_add_u32 v7, v8, 1, v7
    v_lshl_add_u32 v7, v9, 4, v7
    v_add_u32 v51, s52, v7
    v_bfe_u32 v6, v1, 3, 2
    v_lshl_add_u32 v6, v6, 2, s50
    v_lshrrev_b32 v7, 5, v1
    v_lshl_add_u32 v6, v7, 1, v6
    v_mul_u32_u24 v7, 1152, v9
    buffer_load_dwordx4 v28, s[20:23], s54 offen offset:512 lds
    v_lshl_add_u32 v54, v6, 1, v7
    v_lshrrev_b32 v7, 5, v6
    v_lshlrev_b32 v7, 12, v7
    v_bfe_u32 v8, v6, 3, 2
    v_lshl_add_u32 v7, v8, 8, v7
    v_and_b32 v8, 7, v6
    v_lshl_add_u32 v7, v8, 1, v7
    v_lshl_add_u32 v7, v9, 4, v7
    buffer_load_dwordx4 v29, s[20:23], s54 offen offset:1536 lds
    v_add_u32 v52, s52, v7
    s_waitcnt lgkmcnt(0)
    s_barrier
    ds_read_b64_tr_b16 a[0:1], v39 offset:0
    ds_read_b64_tr_b16 a[2:3], v39 offset:4608
    ds_read_b64_tr_b16 a[4:5], v39 offset:32
    ds_read_b64_tr_b16 a[6:7], v39 offset:4640
    ds_read_b64_tr_b16 a[8:9], v42 offset:0
    ds_read_b64_tr_b16 a[10:11], v42 offset:4608
    ds_read_b64_tr_b16 a[12:13], v39 offset:9216
    ds_read_b64_tr_b16 a[14:15], v39 offset:13824
    ds_read_b64_tr_b16 a[16:17], v39 offset:9248
    ds_read_b64_tr_b16 a[18:19], v39 offset:13856
    ds_read_b64_tr_b16 a[20:21], v42 offset:9216
    ds_read_b64_tr_b16 a[22:23], v42 offset:13824
    ds_read_b64_tr_b16 a[24:25], v39 offset:18432
    ds_read_b64_tr_b16 a[26:27], v39 offset:23040
    ds_read_b64_tr_b16 a[28:29], v39 offset:18464
    ds_read_b64_tr_b16 a[30:31], v39 offset:23072
    ds_read_b64_tr_b16 a[32:33], v42 offset:18432
    ds_read_b64_tr_b16 a[34:35], v42 offset:23040
    ds_read_b64_tr_b16 a[36:37], v39 offset:27648
    ds_read_b64_tr_b16 a[38:39], v39 offset:32256
    ds_read_b64_tr_b16 a[40:41], v39 offset:27680
    ds_read_b64_tr_b16 a[42:43], v39 offset:32288
    ds_read_b64_tr_b16 a[44:45], v42 offset:27648
    ds_read_b64_tr_b16 a[46:47], v42 offset:32256
    buffer_load_dwordx4 v30, s[20:23], s54 offen offset:2560 lds
    buffer_load_dwordx4 v31, s[20:23], s54 offen offset:3584 lds
    s_add_u32 m0, s67, 36864
    s_add_u32 s54, s70, 3538944
    s_mov_b32 exec_hi, 0
    buffer_load_dwordx4 v27, s[20:23], s54 offen lds
    s_mov_b32 exec_hi, -1
    buffer_load_dwordx4 v28, s[20:23], s54 offen offset:512 lds
    buffer_load_dwordx4 v29, s[20:23], s54 offen offset:1536 lds
    buffer_load_dwordx4 v30, s[20:23], s54 offen offset:2560 lds
    buffer_load_dwordx4 v31, s[20:23], s54 offen offset:3584 lds
    s_add_u32 m0, s67, 55296
    s_add_u32 s54, s70, 4128768
    s_mov_b32 exec_hi, 0
    buffer_load_dwordx4 v27, s[20:23], s54 offen lds
    s_mov_b32 exec_hi, -1
    buffer_load_dwordx4 v28, s[20:23], s54 offen offset:512 lds
    buffer_load_dwordx4 v29, s[20:23], s54 offen offset:1536 lds
    s_waitcnt lgkmcnt(0)
    s_waitcnt vmcnt(18)
    s_barrier
    v_mfma_f32_16x16x32_bf16 v[156:159], a[0:3], v[60:63], 0
    ds_read_b64_tr_b16 a[48:49], v37 offset:0
    ds_read_b64_tr_b16 a[50:51], v37 offset:4608
    v_mfma_f32_16x16x32_bf16 v[160:163], a[4:7], v[60:63], 0
    ds_read_b64_tr_b16 a[52:53], v37 offset:32
    ds_read_b64_tr_b16 a[54:55], v37 offset:4640
    v_mfma_f32_16x16x32_bf16 v[164:167], a[8:11], v[60:63], 0
    ds_read_b64_tr_b16 a[56:57], v40 offset:0
    ds_read_b64_tr_b16 a[58:59], v40 offset:4608
    v_mfma_f32_16x16x32_bf16 v[156:159], a[12:15], v[60:63], v[156:159]
    ds_read_b64_tr_b16 a[60:61], v37 offset:9216
    ds_read_b64_tr_b16 a[62:63], v37 offset:13824
    v_mfma_f32_16x16x32_bf16 v[160:163], a[16:19], v[60:63], v[160:163]
    ds_read_b64_tr_b16 a[64:65], v37 offset:9248
    ds_read_b64_tr_b16 a[66:67], v37 offset:13856
    v_mfma_f32_16x16x32_bf16 v[164:167], a[20:23], v[60:63], v[164:167]
    ds_read_b64_tr_b16 a[68:69], v40 offset:9216
    ds_read_b64_tr_b16 a[70:71], v40 offset:13824
    v_mfma_f32_16x16x32_bf16 v[156:159], a[24:27], v[60:63], v[156:159]
    ds_read_b64_tr_b16 a[72:73], v37 offset:18432
    ds_read_b64_tr_b16 a[74:75], v37 offset:23040
    v_mfma_f32_16x16x32_bf16 v[160:163], a[28:31], v[60:63], v[160:163]
    ds_read_b64_tr_b16 a[76:77], v37 offset:18464
    ds_read_b64_tr_b16 a[78:79], v37 offset:23072
    v_mfma_f32_16x16x32_bf16 v[164:167], a[32:35], v[60:63], v[164:167]
    ds_read_b64_tr_b16 a[80:81], v40 offset:18432
    ds_read_b64_tr_b16 a[82:83], v40 offset:23040
    v_mfma_f32_16x16x32_bf16 v[156:159], a[36:39], v[60:63], v[156:159]
    ds_read_b64_tr_b16 a[84:85], v37 offset:27648
    ds_read_b64_tr_b16 a[86:87], v37 offset:32256
    v_mfma_f32_16x16x32_bf16 v[160:163], a[40:43], v[60:63], v[160:163]
    ds_read_b64_tr_b16 a[88:89], v37 offset:27680
    ds_read_b64_tr_b16 a[90:91], v37 offset:32288
    v_mfma_f32_16x16x32_bf16 v[164:167], a[44:47], v[60:63], v[164:167]
    ds_read_b64_tr_b16 a[92:93], v40 offset:27648
    ds_read_b64_tr_b16 a[94:95], v40 offset:32256
    buffer_load_dwordx4 v30, s[20:23], s54 offen offset:2560 lds
    buffer_load_dwordx4 v31, s[20:23], s54 offen offset:3584 lds
    s_add_u32 m0, s67, 110592
    s_add_u32 s54, s70, 4718592
    s_mov_b32 exec_hi, 0
    buffer_load_dwordx4 v27, s[20:23], s54 offen lds
    s_mov_b32 exec_hi, -1
    buffer_load_dwordx4 v28, s[20:23], s54 offen offset:512 lds
    buffer_load_dwordx4 v29, s[20:23], s54 offen offset:1536 lds
    buffer_load_dwordx4 v30, s[20:23], s54 offen offset:2560 lds
    buffer_load_dwordx4 v31, s[20:23], s54 offen offset:3584 lds
    s_waitcnt lgkmcnt(0)
    s_waitcnt vmcnt(15)
    s_barrier
    v_mfma_f32_16x16x32_bf16 v[156:159], a[48:51], v[60:63], v[156:159]
    ds_read_b64_tr_b16 a[96:97], v38 offset:18432
    ds_read_b64_tr_b16 a[98:99], v38 offset:23040
    v_mfma_f32_16x16x32_bf16 v[160:163], a[52:55], v[60:63], v[160:163]
    ds_read_b64_tr_b16 a[100:101], v38 offset:18464
    ds_read_b64_tr_b16 a[102:103], v38 offset:23072
    v_mfma_f32_16x16x32_bf16 v[164:167], a[56:59], v[60:63], v[164:167]
    ds_read_b64_tr_b16 a[104:105], v41 offset:18432
    ds_read_b64_tr_b16 a[106:107], v41 offset:23040
    v_mfma_f32_16x16x32_bf16 v[156:159], a[60:63], v[60:63], v[156:159]
    ds_read_b64_tr_b16 a[108:109], v38 offset:27648
    ds_read_b64_tr_b16 a[110:111], v38 offset:32256
    v_mfma_f32_16x16x32_bf16 v[160:163], a[64:67], v[60:63], v[160:163]
    ds_read_b64_tr_b16 a[112:113], v38 offset:27680
    ds_read_b64_tr_b16 a[114:115], v38 offset:32288
    v_mfma_f32_16x16x32_bf16 v[164:167], a[68:71], v[60:63], v[164:167]
    ds_read_b64_tr_b16 a[116:117], v41 offset:27648
    ds_read_b64_tr_b16 a[118:119], v41 offset:32256
    v_mfma_f32_16x16x32_bf16 v[156:159], a[72:75], v[60:63], v[156:159]
    ds_read_b64_tr_b16 a[120:121], v38 offset:36864
    ds_read_b64_tr_b16 a[122:123], v38 offset:41472
    v_mfma_f32_16x16x32_bf16 v[160:163], a[76:79], v[60:63], v[160:163]
    ds_read_b64_tr_b16 a[124:125], v38 offset:36896
    ds_read_b64_tr_b16 a[126:127], v38 offset:41504
    v_mfma_f32_16x16x32_bf16 v[164:167], a[80:83], v[60:63], v[164:167]
    ds_read_b64_tr_b16 a[128:129], v41 offset:36864
    ds_read_b64_tr_b16 a[130:131], v41 offset:41472
    v_mfma_f32_16x16x32_bf16 v[156:159], a[84:87], v[60:63], v[156:159]
    ds_read_b64_tr_b16 a[132:133], v38 offset:46080
    ds_read_b64_tr_b16 a[134:135], v38 offset:50688
    v_mfma_f32_16x16x32_bf16 v[160:163], a[88:91], v[60:63], v[160:163]
    ds_read_b64_tr_b16 a[136:137], v38 offset:46112
    ds_read_b64_tr_b16 a[138:139], v38 offset:50720
    v_mfma_f32_16x16x32_bf16 v[164:167], a[92:95], v[60:63], v[164:167]
    ds_read_b64_tr_b16 a[140:141], v41 offset:46080
    ds_read_b64_tr_b16 a[142:143], v41 offset:50688
    s_waitcnt lgkmcnt(0)
    s_waitcnt vmcnt(5)
    s_barrier
    v_mfma_f32_16x16x32_bf16 v[156:159], a[96:99], v[60:63], v[156:159]
    ds_read_b64_tr_b16 a[144:145], v37 offset:36864
    ds_read_b64_tr_b16 a[146:147], v37 offset:41472
    v_mfma_f32_16x16x32_bf16 v[160:163], a[100:103], v[60:63], v[160:163]
    ds_read_b64_tr_b16 a[148:149], v37 offset:36896
    ds_read_b64_tr_b16 a[150:151], v37 offset:41504
    v_mfma_f32_16x16x32_bf16 v[164:167], a[104:107], v[60:63], v[164:167]
    ds_read_b64_tr_b16 a[152:153], v40 offset:36864
    ds_read_b64_tr_b16 a[154:155], v40 offset:41472
    v_mfma_f32_16x16x32_bf16 v[156:159], a[108:111], v[60:63], v[156:159]
    ds_read_b64_tr_b16 a[156:157], v37 offset:46080
    ds_read_b64_tr_b16 a[158:159], v37 offset:50688
    v_mfma_f32_16x16x32_bf16 v[160:163], a[112:115], v[60:63], v[160:163]
    ds_read_b64_tr_b16 a[160:161], v37 offset:46112
    ds_read_b64_tr_b16 a[162:163], v37 offset:50720
    v_mfma_f32_16x16x32_bf16 v[164:167], a[116:119], v[60:63], v[164:167]
    ds_read_b64_tr_b16 a[164:165], v40 offset:46080
    ds_read_b64_tr_b16 a[166:167], v40 offset:50688
    v_mfma_f32_16x16x32_bf16 v[156:159], a[120:123], v[60:63], v[156:159]
    ds_read_b64_tr_b16 a[168:169], v38 offset:0
    ds_read_b64_tr_b16 a[170:171], v38 offset:4608
    v_mfma_f32_16x16x32_bf16 v[160:163], a[124:127], v[60:63], v[160:163]
    ds_read_b64_tr_b16 a[172:173], v38 offset:32
    ds_read_b64_tr_b16 a[174:175], v38 offset:4640
    v_mfma_f32_16x16x32_bf16 v[164:167], a[128:131], v[60:63], v[164:167]
    ds_read_b64_tr_b16 a[176:177], v41 offset:0
    ds_read_b64_tr_b16 a[178:179], v41 offset:4608
    v_mfma_f32_16x16x32_bf16 v[156:159], a[132:135], v[60:63], v[156:159]
    ds_read_b64_tr_b16 a[180:181], v38 offset:9216
    ds_read_b64_tr_b16 a[182:183], v38 offset:13824
    v_mfma_f32_16x16x32_bf16 v[160:163], a[136:139], v[60:63], v[160:163]
    ds_read_b64_tr_b16 a[184:185], v38 offset:9248
    ds_read_b64_tr_b16 a[186:187], v38 offset:13856
    v_mfma_f32_16x16x32_bf16 v[164:167], a[140:143], v[60:63], v[164:167]
    ds_read_b64_tr_b16 a[188:189], v41 offset:9216
    ds_read_b64_tr_b16 a[190:191], v41 offset:13824
    s_waitcnt lgkmcnt(0)
    s_waitcnt vmcnt(0)
    s_barrier
    v_mfma_f32_16x16x32_bf16 v[156:159], a[144:147], v[60:63], v[156:159]
    ds_read_b64_tr_b16 a[192:193], v39 offset:0
    ds_read_b64_tr_b16 a[194:195], v39 offset:4608
    v_mfma_f32_16x16x32_bf16 v[160:163], a[148:151], v[60:63], v[160:163]
    ds_read_b64_tr_b16 a[196:197], v39 offset:32
    ds_read_b64_tr_b16 a[198:199], v39 offset:4640
    v_mfma_f32_16x16x32_bf16 v[164:167], a[152:155], v[60:63], v[164:167]
    ds_read_b64_tr_b16 a[200:201], v42 offset:0
    ds_read_b64_tr_b16 a[202:203], v42 offset:4608
    v_mfma_f32_16x16x32_bf16 v[156:159], a[156:159], v[60:63], v[156:159]
    ds_read_b64_tr_b16 a[204:205], v39 offset:9216
    ds_read_b64_tr_b16 a[206:207], v39 offset:13824
    v_mfma_f32_16x16x32_bf16 v[160:163], a[160:163], v[60:63], v[160:163]
    ds_read_b64_tr_b16 a[208:209], v39 offset:9248
    ds_read_b64_tr_b16 a[210:211], v39 offset:13856
    v_mfma_f32_16x16x32_bf16 v[164:167], a[164:167], v[60:63], v[164:167]
    ds_read_b64_tr_b16 a[212:213], v42 offset:9216
    ds_read_b64_tr_b16 a[214:215], v42 offset:13824
    v_mfma_f32_16x16x32_bf16 v[156:159], a[168:171], v[60:63], v[156:159]
    v_mfma_f32_16x16x32_bf16 v[160:163], a[172:175], v[60:63], v[160:163]
    v_mfma_f32_16x16x32_bf16 v[164:167], a[176:179], v[60:63], v[164:167]
    v_mfma_f32_16x16x32_bf16 v[156:159], a[180:183], v[60:63], v[156:159]
    v_mfma_f32_16x16x32_bf16 v[160:163], a[184:187], v[60:63], v[160:163]
    v_mfma_f32_16x16x32_bf16 v[164:167], a[188:191], v[60:63], v[164:167]
    s_waitcnt lgkmcnt(6)
    v_mfma_f32_16x16x32_bf16 v[156:159], a[192:195], v[60:63], v[156:159]
    v_mfma_f32_16x16x32_bf16 v[160:163], a[196:199], v[60:63], v[160:163]
    v_mfma_f32_16x16x32_bf16 v[164:167], a[200:203], v[60:63], v[164:167]
    s_waitcnt lgkmcnt(0)
    v_mfma_f32_16x16x32_bf16 v[156:159], a[204:207], v[60:63], v[156:159]
    v_mfma_f32_16x16x32_bf16 v[160:163], a[208:211], v[60:63], v[160:163]
    v_mfma_f32_16x16x32_bf16 v[164:167], a[212:215], v[60:63], v[164:167]
    s_branch L_mlp
L_help:
    s_mov_b32 s38, 268435456
    s_mov_b32 s39, 0x20000
    s_mov_b32 s18, 663552
    s_mov_b32 s19, 0x20000
    s_mov_b32 s22, 5308416
    s_mov_b32 s23, 0x20000
    s_mov_b32 s26, 5308416
    s_mov_b32 s27, 0x20000
    s_mov_b32 s30, 589824
    s_mov_b32 s31, 0x20000
    s_mov_b32 s34, 256
    s_mov_b32 s35, 0x20000
    v_lshlrev_b32 v2, 4, v1
    s_lshr_b32 s42, s41, 2
    s_and_b32 s43, s41, 3
    s_mul_i32 s67, s44, 4608
    s_lshl_b32 s50, s42, 15
    s_lshl_b32 s51, s40, 15
    v_mov_b32 v6, s50
    v_mov_b32 v7, s51
    buffer_load_dword v18, v6, s[36:39], 0 offen sc1
    buffer_load_dword v19, v7, s[36:39], 0 offen sc1
    s_lshl_b32 s57, s41, 3
    s_add_u32 s57, s57, s40
    s_getreg_b32 s47, hwreg(HW_REG_XCC_ID)
    s_and_b32 s47, s47, 7
    s_cmp_eq_u32 s44, 0
    s_cselect_b32 s74, 1, 0
    s_mov_b32 s75, 0
    s_mov_b32 s72, 0xbdd2d3e8
    s_mov_b32 s73, 0xbdd2d3e8
    v_mov_b32 v4, 0xc0135761
    v_mov_b32 v5, 0xc0135761
    v_mov_b32 v60, 0x3f803f80
    v_mov_b32 v61, 0x3f803f80
    v_mov_b32 v62, 0x3f803f80
    v_mov_b32 v63, 0x3f803f80
    s_and_b32 s50, s44, 1
    s_lshl_b32 s50, s50, 2
    s_lshr_b32 s51, s44, 1
    s_lshl_b32 s51, s51, 5
    s_add_u32 s50, s50, s51
    s_mul_i32 s52, s43, 288
    s_mul_i32 s51, s40, 1152
    s_add_u32 s51, s51, s52
    s_mul_i32 s70, s50, 9216
    s_add_u32 s70, s70, s51
    s_mul_i32 s51, s40, 663552
    s_add_u32 s51, s51, s52
    s_mul_i32 s87, s44, 165888
    s_add_u32 s87, s87, s51
    s_add_u32 s87, s87, 147456
    s_mul_i32 s50, s44, 18432
    s_add_u32 s51, s51, s50
    s_add_u32 s50, s43, 0
    s_and_b32 s50, s50, 3
    s_mul_i32 s50, s50, 165888
    s_add_u32 s71, s50, s51
    s_add_u32 s50, s43, 1
    s_and_b32 s50, s50, 3
    s_mul_i32 s50, s50, 165888
    s_add_u32 s88, s50, s51
    s_add_u32 s50, s43, 2
    s_and_b32 s50, s50, 3
    s_mul_i32 s50, s50, 165888
    s_add_u32 s89, s50, s51
    s_add_u32 s50, s43, 3
    s_and_b32 s50, s50, 3
    s_mul_i32 s50, s50, 165888
    s_add_u32 s3, s50, s51
    s_mov_b32 s50, -288
    s_movk_i32 s51, 9216
    s_movk_i32 s52, 1152
    v_mul_u32_u24 v8, 3641, v1
    v_lshrrev_b32 v7, 16, v8
    v_mad_i32_i24 v6, v7, s50, v2
    v_mad_u32_u24 v32, v7, s52, v6
    v_and_b32 v27, 12, v7
    v_add_u32 v7, v7, v27
    v_mad_u32_u24 v27, v7, s51, v6
    v_add_u32 v7, 116512, v8
    v_lshrrev_b32 v7, 16, v7
    v_mad_i32_i24 v6, v7, s50, v2
    v_mad_u32_u24 v33, v7, s52, v6
    v_and_b32 v28, 12, v7
    v_add_u32 v7, v7, v28
    v_mad_u32_u24 v28, v7, s51, v6
    v_add_u32 v7, 349536, v8
    v_lshrrev_b32 v7, 16, v7
    v_mad_i32_i24 v6, v7, s50, v2
    v_mad_u32_u24 v34, v7, s52, v6
    v_and_b32 v29, 12, v7
    v_add_u32 v7, v7, v29
    v_mad_u32_u24 v29, v7, s51, v6
    v_add_u32 v7, 582560, v8
    v_lshrrev_b32 v7, 16, v7
    v_mad_i32_i24 v6, v7, s50, v2
    v_mad_u32_u24 v35, v7, s52, v6
    v_and_b32 v30, 12, v7
    v_add_u32 v7, v7, v30
    v_mad_u32_u24 v30, v7, s51, v6
    v_add_u32 v7, 815584, v8
    v_lshrrev_b32 v7, 16, v7
    v_mad_i32_i24 v6, v7, s50, v2
    v_mad_u32_u24 v36, v7, s52, v6
    v_and_b32 v31, 12, v7
    v_add_u32 v7, v7, v31
    v_mad_u32_u24 v31, v7, s51, v6
    v_lshrrev_b32 v6, 2, v1
    v_mul_u32_u24 v6, 288, v6
    v_and_b32 v7, 3, v1
    v_lshl_add_u32 v6, v7, 3, v6
    s_lshl_b32 s50, s44, 6
    v_add_u32 v37, s50, v6
    v_add_u32 v40, 256, v6
    v_add_u32 v38, 55296, v37
    v_add_u32 v41, 55296, v40
    v_add_u32 v39, 110592, v37
    v_add_u32 v42, 110592, v40
    v_and_b32 v8, 15, v1
    v_lshlrev_b32 v8, 3, v8
    s_add_u32 s50, s44, 0
    s_and_b32 s50, s50, 3
    s_lshl_b32 s51, s50, 10
    v_add_u32 v43, s51, v2
    v_add_u32 v47, 0x10000, v43
    s_lshl_b32 s51, s50, 7
    s_add_u32 s51, s51, 147456
    v_add_u32 v55, s51, v8
    s_add_u32 s50, s44, 1
    s_and_b32 s50, s50, 3
    s_lshl_b32 s51, s50, 10
    v_add_u32 v44, s51, v2
    v_add_u32 v48, 0x10000, v44
    s_lshl_b32 s51, s50, 7
    s_add_u32 s51, s51, 147456
    v_add_u32 v56, s51, v8
    s_add_u32 s50, s44, 2
    s_and_b32 s50, s50, 3
    s_lshl_b32 s51, s50, 10
    v_add_u32 v45, s51, v2
    v_add_u32 v49, 0x10000, v45
    s_lshl_b32 s51, s50, 7
    s_add_u32 s51, s51, 147456
    v_add_u32 v57, s51, v8
    s_add_u32 s50, s44, 3
    s_and_b32 s50, s50, 3
    s_lshl_b32 s51, s50, 10
    v_add_u32 v46, s51, v2
    v_add_u32 v50, 0x10000, v46
    s_lshl_b32 s51, s50, 7
    s_add_u32 s51, s51, 147456
    v_add_u32 v58, s51, v8
    s_lshl_b32 s68, s40, 3
    s_add_u32 s68, s68, s42
    s_mul_i32 s68, s68, 73728
    s_add_u32 s68, s68, 2097152
    s_mul_i32 s50, s43, 144
    s_lshl_b32 s51, s44, 5
    s_add_u32 s51, s51, s50
    s_add_u32 s50, s50, 128
    s_lshr_b32 s52, s40, 1
    s_lshl_b32 s52, s52, 10
    s_and_b32 s53, s40, 1
    s_lshl_b32 s53, s53, 7
    s_add_u32 s52, s52, s53
    v_and_b32 v9, 7, v1
    v_lshrrev_b32 v6, 3, v1
    v_lshl_add_u32 v6, v6, 2, s51
    v_mul_u32_u24 v7, 1152, v9
    v_lshl_add_u32 v53, v6, 1, v7
    v_lshrrev_b32 v7, 5, v6
    v_lshlrev_b32 v7, 12, v7
    v_bfe_u32 v8, v6, 3, 2
    v_lshl_add_u32 v7, v8, 8, v7
    v_and_b32 v8, 7, v6
    v_lshl_add_u32 v7, v8, 1, v7
    v_lshl_add_u32 v7, v9, 4, v7
    v_add_u32 v51, s52, v7
    v_bfe_u32 v6, v1, 3, 2
    v_lshl_add_u32 v6, v6, 2, s50
    v_lshrrev_b32 v7, 5, v1
    v_lshl_add_u32 v6, v7, 1, v6
    v_mul_u32_u24 v7, 1152, v9
    v_lshl_add_u32 v54, v6, 1, v7
    v_lshrrev_b32 v7, 5, v6
    v_lshlrev_b32 v7, 12, v7
    v_bfe_u32 v8, v6, 3, 2
    v_lshl_add_u32 v7, v8, 8, v7
    v_and_b32 v8, 7, v6
    v_lshl_add_u32 v7, v8, 1, v7
    v_lshl_add_u32 v7, v9, 4, v7
    v_add_u32 v52, s52, v7
    s_add_u32 s83, s82, 458752
    s_lshl_b32 s53, s81, 6
    v_add_u32 v6, s53, v1
    v_mul_u32_u24 v7, 7282, v6
    v_lshrrev_b32 v7, 16, v7
    v_mul_u32_u24 v8, 9, v7
    v_sub_u32 v6, v6, v8
    v_mul_u32_u24 v7, 9216, v7
    v_lshl_add_u32 v16, v6, 7, v7
    s_lshl_b32 s53, s81, 6
    s_add_u32 s53, s53, 3584
    v_add_u32 v6, s53, v1
    v_mul_u32_u24 v7, 7282, v6
    v_lshrrev_b32 v7, 16, v7
    v_mul_u32_u24 v8, 9, v7
    v_sub_u32 v6, v6, v8
    v_mul_u32_u24 v7, 9216, v7
    v_lshl_add_u32 v17, v6, 7, v7
    s_mul_i32 s53, s40, 1152
    s_mul_i32 s58, s40, 73728
    s_add_u32 s58, s58, s82
    s_add_u32 s58, s58, -122880
    s_cmp_ge_u32 s81, 47
    s_cselect_b32 s58, s58, 0x7fffffff
    s_waitcnt vmcnt(0)
    v_readfirstlane_b32 s48, v18
    v_readfirstlane_b32 s49, v19
    s_nop 0
    s_add_u32 s48, s48, 1
    s_add_u32 s49, s49, 1
    buffer_load_dword v73, v14, s[16:19], s82 offen
    buffer_load_dword v74, v14, s[16:19], s83 offen
    buffer_load_dword v79, v14, s[36:39], s58 offen
    buffer_load_dword v75, v16, s[20:23], s53 offen
    buffer_load_dword v76, v17, s[20:23], s53 offen
    s_add_u32 m0, s67, 0
    s_add_u32 s54, s70, 0
    s_mov_b32 exec_hi, 0
    buffer_load_dwordx4 v27, s[20:23], s54 offen lds
    s_mov_b32 exec_hi, -1
    buffer_load_dwordx4 v28, s[20:23], s54 offen offset:512 lds
    buffer_load_dwordx4 v29, s[20:23], s54 offen offset:1536 lds
    buffer_load_dwordx4 v30, s[20:23], s54 offen offset:2560 lds
    buffer_load_dwordx4 v31, s[20:23], s54 offen offset:3584 lds
    s_add_u32 m0, s67, 18432
    s_add_u32 s54, s70, 589824
    s_mov_b32 exec_hi, 0
    buffer_load_dwordx4 v27, s[20:23], s54 offen lds
    s_mov_b32 exec_hi, -1
    buffer_load_dwordx4 v28, s[20:23], s54 offen offset:512 lds
    buffer_load_dwordx4 v29, s[20:23], s54 offen offset:1536 lds
    buffer_load_dwordx4 v30, s[20:23], s54 offen offset:2560 lds
    buffer_load_dwordx4 v31, s[20:23], s54 offen offset:3584 lds
    s_add_u32 m0, s67, 36864
    s_add_u32 s54, s70, 1179648
    s_mov_b32 exec_hi, 0
    buffer_load_dwordx4 v27, s[20:23], s54 offen lds
    s_mov_b32 exec_hi, -1
    buffer_load_dwordx4 v28, s[20:23], s54 offen offset:512 lds
    buffer_load_dwordx4 v29, s[20:23], s54 offen offset:1536 lds
    buffer_load_dwordx4 v30, s[20:23], s54 offen offset:2560 lds
    buffer_load_dwordx4 v31, s[20:23], s54 offen offset:3584 lds
    s_add_u32 m0, s67, 55296
    s_add_u32 s54, s70, 1769472
    s_mov_b32 exec_hi, 0
    buffer_load_dwordx4 v27, s[20:23], s54 offen lds
    s_mov_b32 exec_hi, -1
    buffer_load_dwordx4 v28, s[20:23], s54 offen offset:512 lds
    buffer_load_dwordx4 v29, s[20:23], s54 offen offset:1536 lds
    buffer_load_dwordx4 v30, s[20:23], s54 offen offset:2560 lds
    buffer_load_dwordx4 v31, s[20:23], s54 offen offset:3584 lds
    s_waitcnt vmcnt(10)
    s_barrier
    ds_read_b64_tr_b16 a[0:1], v37 offset:0
    ds_read_b64_tr_b16 a[2:3], v37 offset:4608
    ds_read_b64_tr_b16 a[4:5], v37 offset:32
    ds_read_b64_tr_b16 a[6:7], v37 offset:4640
    ds_read_b64_tr_b16 a[8:9], v40 offset:0
    ds_read_b64_tr_b16 a[10:11], v40 offset:4608
    ds_read_b64_tr_b16 a[12:13], v37 offset:9216
    ds_read_b64_tr_b16 a[14:15], v37 offset:13824
    ds_read_b64_tr_b16 a[16:17], v37 offset:9248
    ds_read_b64_tr_b16 a[18:19], v37 offset:13856
    ds_read_b64_tr_b16 a[20:21], v40 offset:9216
    ds_read_b64_tr_b16 a[22:23], v40 offset:13824
    ds_read_b64_tr_b16 a[24:25], v37 offset:18432
    ds_read_b64_tr_b16 a[26:27], v37 offset:23040
    s_waitcnt lgkmcnt(8)
    v_mfma_f32_16x16x32_bf16 v[156:159], a[0:3], v[60:63], 0
    ds_read_b64_tr_b16 a[28:29], v37 offset:18464
    ds_read_b64_tr_b16 a[30:31], v37 offset:23072
    v_mfma_f32_16x16x32_bf16 v[160:163], a[4:7], v[60:63], 0
    ds_read_b64_tr_b16 a[32:33], v40 offset:18432
    ds_read_b64_tr_b16 a[34:35], v40 offset:23040
    v_mfma_f32_16x16x32_bf16 v[164:167], a[8:11], v[60:63], 0
    ds_read_b64_tr_b16 a[36:37], v37 offset:27648
    ds_read_b64_tr_b16 a[38:39], v37 offset:32256
    s_waitcnt lgkmcnt(8)
    v_mfma_f32_16x16x32_bf16 v[156:159], a[12:15], v[60:63], v[156:159]
    ds_read_b64_tr_b16 a[40:41], v37 offset:27680
    ds_read_b64_tr_b16 a[42:43], v37 offset:32288
    v_mfma_f32_16x16x32_bf16 v[160:163], a[16:19], v[60:63], v[160:163]
    ds_read_b64_tr_b16 a[44:45], v40 offset:27648
    ds_read_b64_tr_b16 a[46:47], v40 offset:32256
    v_mfma_f32_16x16x32_bf16 v[164:167], a[20:23], v[60:63], v[164:167]
    s_add_u32 m0, s67, 73728
    s_add_u32 s54, s70, 2359296
    s_waitcnt lgkmcnt(6)
    v_mfma_f32_16x16x32_bf16 v[156:159], a[24:27], v[60:63], v[156:159]
    s_mov_b32 exec_hi, 0
    buffer_load_dwordx4 v27, s[20:23], s54 offen lds
    s_mov_b32 exec_hi, -1
    v_mfma_f32_16x16x32_bf16 v[160:163], a[28:31], v[60:63], v[160:163]
    v_mfma_f32_16x16x32_bf16 v[164:167], a[32:35], v[60:63], v[164:167]
    s_waitcnt lgkmcnt(0)
    v_mfma_f32_16x16x32_bf16 v[156:159], a[36:39], v[60:63], v[156:159]
    v_mfma_f32_16x16x32_bf16 v[160:163], a[40:43], v[60:63], v[160:163]
    buffer_load_dwordx4 v28, s[20:23], s54 offen offset:512 lds
    v_mfma_f32_16x16x32_bf16 v[164:167], a[44:47], v[60:63], v[164:167]
    buffer_load_dwordx4 v29, s[20:23], s54 offen offset:1536 lds
    buffer_load_dwordx4 v30, s[20:23], s54 offen offset:2560 lds
    buffer_load_dwordx4 v31, s[20:23], s54 offen offset:3584 lds
    s_add_u32 m0, s67, 92160
    s_add_u32 s54, s70, 2949120
    s_mov_b32 exec_hi, 0
    buffer_load_dwordx4 v27, s[20:23], s54 offen lds
    s_mov_b32 exec_hi, -1
    buffer_load_dwordx4 v28, s[20:23], s54 offen offset:512 lds
    buffer_load_dwordx4 v29, s[20:23], s54 offen offset:1536 lds
    buffer_load_dwordx4 v30, s[20:23], s54 offen offset:2560 lds
    buffer_load_dwordx4 v31, s[20:23], s54 offen offset:3584 lds
    s_add_u32 m0, s67, 110592
    s_add_u32 s54, s70, 3538944
    s_mov_b32 exec_hi, 0
    buffer_load_dwordx4 v27, s[20:23], s54 offen lds
    s_mov_b32 exec_hi, -1
    buffer_load_dwordx4 v28, s[20:23], s54 offen offset:512 lds
    buffer_load_dwordx4 v29, s[20:23], s54 offen offset:1536 lds
    buffer_load_dwordx4 v30, s[20:23], s54 offen offset:2560 lds
    buffer_load_dwordx4 v31, s[20:23], s54 offen offset:3584 lds
    s_add_u32 m0, s67, 129024
    s_add_u32 s54, s70, 4128768
    s_mov_b32 exec_hi, 0
    buffer_load_dwordx4 v27, s[20:23], s54 offen lds
    s_mov_b32 exec_hi, -1
    buffer_load_dwordx4 v28, s[20:23], s54 offen offset:512 lds
    buffer_load_dwordx4 v29, s[20:23], s54 offen offset:1536 lds
    buffer_load_dwordx4 v30, s[20:23], s54 offen offset:2560 lds
    buffer_load_dwordx4 v31, s[20:23], s54 offen offset:3584 lds
    s_waitcnt vmcnt(15)
    s_barrier
    s_add_u32 m0, s67, 0
    s_add_u32 s54, s70, 4718592
    s_mov_b32 exec_hi, 0
    buffer_load_dwordx4 v27, s[20:23], s54 offen lds
    s_mov_b32 exec_hi, -1
    buffer_load_dwordx4 v28, s[20:23], s54 offen offset:512 lds
    buffer_load_dwordx4 v29, s[20:23], s54 offen offset:1536 lds
    buffer_load_dwordx4 v30, s[20:23], s54 offen offset:2560 lds
    buffer_load_dwordx4 v31, s[20:23], s54 offen offset:3584 lds
    ds_read_b64_tr_b16 a[48:49], v37 offset:36864
    ds_read_b64_tr_b16 a[50:51], v37 offset:41472
    ds_read_b64_tr_b16 a[52:53], v37 offset:36896
    ds_read_b64_tr_b16 a[54:55], v37 offset:41504
    ds_read_b64_tr_b16 a[56:57], v40 offset:36864
    ds_read_b64_tr_b16 a[58:59], v40 offset:41472
    ds_read_b64_tr_b16 a[60:61], v37 offset:46080
    ds_read_b64_tr_b16 a[62:63], v37 offset:50688
    ds_read_b64_tr_b16 a[64:65], v37 offset:46112
    ds_read_b64_tr_b16 a[66:67], v37 offset:50720
    ds_read_b64_tr_b16 a[68:69], v40 offset:46080
    ds_read_b64_tr_b16 a[70:71], v40 offset:50688
    ds_read_b64_tr_b16 a[72:73], v38 offset:0
    ds_read_b64_tr_b16 a[74:75], v38 offset:4608
    s_waitcnt lgkmcnt(8)
    v_mfma_f32_16x16x32_bf16 v[156:159], a[48:51], v[60:63], v[156:159]
    ds_read_b64_tr_b16 a[76:77], v38 offset:32
    ds_read_b64_tr_b16 a[78:79], v38 offset:4640
    v_mfma_f32_16x16x32_bf16 v[160:163], a[52:55], v[60:63], v[160:163]
    ds_read_b64_tr_b16 a[80:81], v41 offset:0
    ds_read_b64_tr_b16 a[82:83], v41 offset:4608
    v_mfma_f32_16x16x32_bf16 v[164:167], a[56:59], v[60:63], v[164:167]
    ds_read_b64_tr_b16 a[84:85], v38 offset:9216
    ds_read_b64_tr_b16 a[86:87], v38 offset:13824
    s_waitcnt lgkmcnt(8)
    v_mfma_f32_16x16x32_bf16 v[156:159], a[60:63], v[60:63], v[156:159]
    ds_read_b64_tr_b16 a[88:89], v38 offset:9248
    ds_read_b64_tr_b16 a[90:91], v38 offset:13856
    v_mfma_f32_16x16x32_bf16 v[160:163], a[64:67], v[60:63], v[160:163]
    ds_read_b64_tr_b16 a[92:93], v41 offset:9216
    ds_read_b64_tr_b16 a[94:95], v41 offset:13824
    v_mfma_f32_16x16x32_bf16 v[164:167], a[68:71], v[60:63], v[164:167]
    ds_read_b64_tr_b16 a[96:97], v38 offset:18432
    ds_read_b64_tr_b16 a[98:99], v38 offset:23040
    s_waitcnt lgkmcnt(8)
    v_mfma_f32_16x16x32_bf16 v[156:159], a[72:75], v[60:63], v[156:159]
    ds_read_b64_tr_b16 a[100:101], v38 offset:18464
    ds_read_b64_tr_b16 a[102:103], v38 offset:23072
    v_mfma_f32_16x16x32_bf16 v[160:163], a[76:79], v[60:63], v[160:163]
    ds_read_b64_tr_b16 a[104:105], v41 offset:18432
    ds_read_b64_tr_b16 a[106:107], v41 offset:23040
    v_mfma_f32_16x16x32_bf16 v[164:167], a[80:83], v[60:63], v[164:167]
    ds_read_b64_tr_b16 a[108:109], v38 offset:27648
    ds_read_b64_tr_b16 a[110:111], v38 offset:32256
    s_waitcnt lgkmcnt(8)
    v_mfma_f32_16x16x32_bf16 v[156:159], a[84:87], v[60:63], v[156:159]
    ds_read_b64_tr_b16 a[112:113], v38 offset:27680
    ds_read_b64_tr_b16 a[114:115], v38 offset:32288
    v_mfma_f32_16x16x32_bf16 v[160:163], a[88:91], v[60:63], v[160:163]
    ds_read_b64_tr_b16 a[116:117], v41 offset:27648
    ds_read_b64_tr_b16 a[118:119], v41 offset:32256
    v_mfma_f32_16x16x32_bf16 v[164:167], a[92:95], v[60:63], v[164:167]
    s_waitcnt lgkmcnt(6)
    v_mfma_f32_16x16x32_bf16 v[156:159], a[96:99], v[60:63], v[156:159]
    v_mfma_f32_16x16x32_bf16 v[160:163], a[100:103], v[60:63], v[160:163]
    v_mfma_f32_16x16x32_bf16 v[164:167], a[104:107], v[60:63], v[164:167]
    s_waitcnt lgkmcnt(0)
    v_mfma_f32_16x16x32_bf16 v[156:159], a[108:111], v[60:63], v[156:159]
    v_mfma_f32_16x16x32_bf16 v[160:163], a[112:115], v[60:63], v[160:163]
    v_mfma_f32_16x16x32_bf16 v[164:167], a[116:119], v[60:63], v[164:167]
    s_waitcnt vmcnt(10)
    s_barrier
    ds_read_b64_tr_b16 a[120:121], v38 offset:36864
    ds_read_b64_tr_b16 a[122:123], v38 offset:41472
    ds_read_b64_tr_b16 a[124:125], v38 offset:36896
    ds_read_b64_tr_b16 a[126:127], v38 offset:41504
    ds_read_b64_tr_b16 a[128:129], v41 offset:36864
    ds_read_b64_tr_b16 a[130:131], v41 offset:41472
    ds_read_b64_tr_b16 a[132:133], v38 offset:46080
    ds_read_b64_tr_b16 a[134:135], v38 offset:50688
    ds_read_b64_tr_b16 a[136:137], v38 offset:46112
    ds_read_b64_tr_b16 a[138:139], v38 offset:50720
    ds_read_b64_tr_b16 a[140:141], v41 offset:46080
    ds_read_b64_tr_b16 a[142:143], v41 offset:50688
    ds_read_b64_tr_b16 a[144:145], v39 offset:0
    ds_read_b64_tr_b16 a[146:147], v39 offset:4608
    s_waitcnt lgkmcnt(8)
    v_mfma_f32_16x16x32_bf16 v[156:159], a[120:123], v[60:63], v[156:159]
    ds_read_b64_tr_b16 a[148:149], v39 offset:32
    ds_read_b64_tr_b16 a[150:151], v39 offset:4640
    v_mfma_f32_16x16x32_bf16 v[160:163], a[124:127], v[60:63], v[160:163]
    ds_read_b64_tr_b16 a[152:153], v42 offset:0
    ds_read_b64_tr_b16 a[154:155], v42 offset:4608
    v_mfma_f32_16x16x32_bf16 v[164:167], a[128:131], v[60:63], v[164:167]
    ds_read_b64_tr_b16 a[156:157], v39 offset:9216
    ds_read_b64_tr_b16 a[158:159], v39 offset:13824
    s_waitcnt lgkmcnt(8)
    v_mfma_f32_16x16x32_bf16 v[156:159], a[132:135], v[60:63], v[156:159]
    ds_read_b64_tr_b16 a[160:161], v39 offset:9248
    ds_read_b64_tr_b16 a[162:163], v39 offset:13856
    v_mfma_f32_16x16x32_bf16 v[160:163], a[136:139], v[60:63], v[160:163]
    ds_read_b64_tr_b16 a[164:165], v42 offset:9216
    ds_read_b64_tr_b16 a[166:167], v42 offset:13824
    v_mfma_f32_16x16x32_bf16 v[164:167], a[140:143], v[60:63], v[164:167]
    s_waitcnt lgkmcnt(6)
    v_mfma_f32_16x16x32_bf16 v[156:159], a[144:147], v[60:63], v[156:159]
    v_mfma_f32_16x16x32_bf16 v[160:163], a[148:151], v[60:63], v[160:163]
    v_mfma_f32_16x16x32_bf16 v[164:167], a[152:155], v[60:63], v[164:167]
    s_waitcnt lgkmcnt(0)
    v_mfma_f32_16x16x32_bf16 v[156:159], a[156:159], v[60:63], v[156:159]
    v_mfma_f32_16x16x32_bf16 v[160:163], a[160:163], v[60:63], v[160:163]
    v_mfma_f32_16x16x32_bf16 v[164:167], a[164:167], v[60:63], v[164:167]
    s_waitcnt vmcnt(0)
    s_barrier
    s_mul_i32 s50, s40, 663552
    s_add_u32 s51, s50, s83
    s_add_u32 s50, s50, s82
    s_cmp_lt_u32 s81, 25
    s_cselect_b32 s51, s51, 0x7fffffff
    buffer_load_dword v77, v14, s[24:27], s50 offen
    buffer_load_dword v78, v14, s[24:27], s51 offen
    ds_read_b64_tr_b16 a[168:169], v39 offset:18432
    ds_read_b64_tr_b16 a[170:171], v39 offset:23040
    ds_read_b64_tr_b16 a[172:173], v39 offset:18464
    ds_read_b64_tr_b16 a[174:175], v39 offset:23072
    ds_read_b64_tr_b16 a[176:177], v42 offset:18432
    ds_read_b64_tr_b16 a[178:179], v42 offset:23040
    ds_read_b64_tr_b16 a[180:181], v39 offset:27648
    ds_read_b64_tr_b16 a[182:183], v39 offset:32256
    ds_read_b64_tr_b16 a[184:185], v39 offset:27680
    ds_read_b64_tr_b16 a[186:187], v39 offset:32288
    ds_read_b64_tr_b16 a[188:189], v42 offset:27648
    ds_read_b64_tr_b16 a[190:191], v42 offset:32256
    ds_read_b64_tr_b16 a[192:193], v37 offset:0
    ds_read_b64_tr_b16 a[194:195], v37 offset:4608
    s_waitcnt lgkmcnt(8)
    v_mfma_f32_16x16x32_bf16 v[156:159], a[168:171], v[60:63], v[156:159]
    ds_read_b64_tr_b16 a[196:197], v37 offset:32
    ds_read_b64_tr_b16 a[198:199], v37 offset:4640
    v_mfma_f32_16x16x32_bf16 v[160:163], a[172:175], v[60:63], v[160:163]
    ds_read_b64_tr_b16 a[200:201], v40 offset:0
    ds_read_b64_tr_b16 a[202:203], v40 offset:4608
    v_mfma_f32_16x16x32_bf16 v[164:167], a[176:179], v[60:63], v[164:167]
    ds_read_b64_tr_b16 a[204:205], v37 offset:9216
    ds_read_b64_tr_b16 a[206:207], v37 offset:13824
    s_waitcnt lgkmcnt(8)
    v_mfma_f32_16x16x32_bf16 v[156:159], a[180:183], v[60:63], v[156:159]
    ds_read_b64_tr_b16 a[208:209], v37 offset:9248
    ds_read_b64_tr_b16 a[210:211], v37 offset:13856
    v_mfma_f32_16x16x32_bf16 v[160:163], a[184:187], v[60:63], v[160:163]
    ds_read_b64_tr_b16 a[212:213], v40 offset:9216
    ds_read_b64_tr_b16 a[214:215], v40 offset:13824
    v_mfma_f32_16x16x32_bf16 v[164:167], a[188:191], v[60:63], v[164:167]
    s_waitcnt lgkmcnt(6)
    v_mfma_f32_16x16x32_bf16 v[156:159], a[192:195], v[60:63], v[156:159]
    v_mfma_f32_16x16x32_bf16 v[160:163], a[196:199], v[60:63], v[160:163]
    v_mfma_f32_16x16x32_bf16 v[164:167], a[200:203], v[60:63], v[164:167]
    s_waitcnt lgkmcnt(0)
    v_mfma_f32_16x16x32_bf16 v[156:159], a[204:207], v[60:63], v[156:159]
    v_mfma_f32_16x16x32_bf16 v[160:163], a[208:211], v[60:63], v[160:163]
    v_mfma_f32_16x16x32_bf16 v[164:167], a[212:215], v[60:63], v[164:167]
L_mlp:
    s_lshl_b32 s58, s42, 15
    s_add_u32 s58, s58, 16384
    s_mul_i32 s59, s42, 73728
    s_add_u32 s59, s59, 1048576
    v_and_b32 v15, 15, v1
    v_lshlrev_b32 v15, 4, v15
    v_lshrrev_b32 v14, 4, v1
    v_lshl_add_u32 v14, v14, 9, v15
    v_add_u32 v15, 4096, v15
    s_lshr_b32 s50, s44, 1
    s_mul_i32 s50, s50, 4608
    s_and_b32 s51, s44, 1
    s_lshl_b32 s51, s51, 8
    s_add_u32 s50, s50, s51
    s_add_u32 s78, s58, s50
    s_cmp_lg_u32 s44, 0
    s_cbranch_scc1 f2done_6
    v_min_u32 v6, 17, v1
    v_lshlrev_b32 v6, 9, v6
    s_mov_b32 s55, 0
f2poll_5:
    buffer_load_dword v7, v6, s[36:39], s58 offen sc1
    s_add_u32 s55, s55, 1
    s_waitcnt vmcnt(0)
    v_cmp_ne_u32 vcc, s48, v7
    s_nop 4
    s_cbranch_vccz f2done_6
    s_cmp_lt_u32 s55, 0x20000
    s_cbranch_scc1 f2poll_5
f2done_6:
    s_barrier
    s_add_u32 m0, s66, 0
    s_add_u32 s54, s66, s59
    buffer_load_dwordx4 v2, s[36:39], s54 offen sc1 lds
    s_add_u32 m0, m0, 4096
    s_add_u32 s54, s54, 4096
    buffer_load_dwordx4 v2, s[36:39], s54 offen sc1 lds
    s_add_u32 m0, m0, 4096
    s_add_u32 s54, s54, 4096
    buffer_load_dwordx4 v2, s[36:39], s54 offen sc1 lds
    s_add_u32 m0, m0, 4096
    s_add_u32 s54, s54, 4096
    buffer_load_dwordx4 v2, s[36:39], s54 offen sc1 lds
    s_add_u32 m0, m0, 4096
    s_add_u32 s54, s54, 4096
    buffer_load_dwordx4 v2, s[36:39], s54 offen sc1 lds
    s_add_u32 m0, m0, 4096
    s_add_u32 s54, s54, 4096
    buffer_load_dwordx4 v2, s[36:39], s54 offen sc1 lds
    s_add_u32 m0, m0, 4096
    s_add_u32 s54, s54, 4096
    buffer_load_dwordx4 v2, s[36:39], s54 offen sc1 lds
    s_add_u32 m0, m0, 4096
    s_add_u32 s54, s54, 4096
    buffer_load_dwordx4 v2, s[36:39], s54 offen sc1 lds
    s_mul_i32 s50, s43, 18432
    s_add_u32 s50, s50, s67
    s_add_u32 s80, s50, s68
    v_min_u32 v10, 35, v1
    v_lshlrev_b32 v10, 7, v10
    s_lshl_b32 s81, s43, 14
    s_lshl_b32 s82, s44, 12
    s_add_u32 s81, s81, s82
    s_add_u32 s81, s81, s68
    s_lshr_b32 s50, s43, 1
    s_lshl_b32 s50, s50, 12
    s_and_b32 s51, s43, 1
    s_lshl_b32 s51, s51, 3
    s_add_u32 s50, s50, s51
    s_add_u32 s83, s50, s68
    v_add_u32 v64, s82, v43
    v_add_u32 v65, s82, v44
    v_add_u32 v66, s82, v45
    v_add_u32 v67, s82, v46
    s_waitcnt vmcnt(5)
    s_barrier
    ds_read_b128 v[72:75], v43 offset:0
    ds_read_b128 v[76:79], v44 offset:0
    ds_read_b128 v[80:83], v45 offset:0
    ds_read_b128 v[84:87], v46 offset:0
    ds_read_b128 v[88:91], v43 offset:4096
    ds_read_b128 v[92:95], v44 offset:4096
    ds_read_b128 v[96:99], v45 offset:4096
    ds_read_b128 v[100:103], v46 offset:4096
    s_waitcnt lgkmcnt(6)
    v_mfma_f32_16x16x32_bf16 v[120:123], a[0:3], v[72:75], 0
    s_add_u32 m0, m0, 4096
    ds_read_b128 v[104:107], v43 offset:8192
    s_add_u32 s54, s54, 4096
    v_mfma_f32_16x16x32_bf16 v[136:139], a[4:7], v[72:75], 0
    v_mfma_f32_16x16x32_bf16 v[152:155], a[8:11], v[72:75], 0
    v_mfma_f32_16x16x32_bf16 v[124:127], a[0:3], v[76:79], 0
    ds_read_b128 v[108:111], v44 offset:8192
    buffer_load_dwordx4 v2, s[36:39], s54 offen sc1 lds
    v_mfma_f32_16x16x32_bf16 v[140:143], a[4:7], v[76:79], 0
    s_add_u32 m0, m0, 4096
    s_add_u32 s54, s54, 4096
    s_waitcnt lgkmcnt(4)
    v_mfma_f32_16x16x32_bf16 v[128:131], a[0:3], v[80:83], 0
    ds_read_b128 v[112:115], v45 offset:8192
    v_mfma_f32_16x16x32_bf16 v[144:147], a[4:7], v[80:83], 0
    v_mfma_f32_16x16x32_bf16 v[132:135], a[0:3], v[84:87], 0
    ds_read_b128 v[116:119], v46 offset:8192
    buffer_load_dwordx4 v2, s[36:39], s54 offen sc1 lds
    v_mfma_f32_16x16x32_bf16 v[148:151], a[4:7], v[84:87], 0
    s_add_u32 m0, m0, 4096
    s_add_u32 s54, s54, 4096
    v_mfma_f32_16x16x32_bf16 v[120:123], a[12:15], v[88:91], v[120:123]
    s_waitcnt vmcnt(5)
    s_barrier
    ds_read_b128 v[72:75], v43 offset:12288
    v_mfma_f32_16x16x32_bf16 v[136:139], a[16:19], v[88:91], v[136:139]
    v_mfma_f32_16x16x32_bf16 v[152:155], a[20:23], v[88:91], v[152:155]
    buffer_load_dwordx4 v2, s[36:39], s54 offen sc1 lds
    s_add_u32 m0, m0, 4096
    v_mfma_f32_16x16x32_bf16 v[124:127], a[12:15], v[92:95], v[124:127]
    s_add_u32 s54, s54, 4096
    ds_read_b128 v[76:79], v44 offset:12288
    v_mfma_f32_16x16x32_bf16 v[140:143], a[16:19], v[92:95], v[140:143]
    s_waitcnt lgkmcnt(4)
    v_mfma_f32_16x16x32_bf16 v[128:131], a[12:15], v[96:99], v[128:131]
    ds_read_b128 v[80:83], v45 offset:12288
    v_mfma_f32_16x16x32_bf16 v[144:147], a[16:19], v[96:99], v[144:147]
    buffer_load_dwordx4 v2, s[36:39], s54 offen sc1 lds
    s_add_u32 m0, m0, 4096
    v_mfma_f32_16x16x32_bf16 v[132:135], a[12:15], v[100:103], v[132:135]
    s_add_u32 s54, s54, 4096
    ds_read_b128 v[84:87], v46 offset:12288
    v_mfma_f32_16x16x32_bf16 v[148:151], a[16:19], v[100:103], v[148:151]
    v_mfma_f32_16x16x32_bf16 v[120:123], a[24:27], v[104:107], v[120:123]
    ds_read_b128 v[88:91], v43 offset:16384
    v_mfma_f32_16x16x32_bf16 v[136:139], a[28:31], v[104:107], v[136:139]
    buffer_load_dwordx4 v2, s[36:39], s54 offen sc1 lds
    s_add_u32 m0, m0, 4096
    v_mfma_f32_16x16x32_bf16 v[152:155], a[32:35], v[104:107], v[152:155]
    s_add_u32 s54, s54, 4096
    v_mfma_f32_16x16x32_bf16 v[124:127], a[24:27], v[108:111], v[124:127]
    ds_read_b128 v[92:95], v44 offset:16384
    v_mfma_f32_16x16x32_bf16 v[140:143], a[28:31], v[108:111], v[140:143]
    s_waitcnt lgkmcnt(4)
    v_mfma_f32_16x16x32_bf16 v[128:131], a[24:27], v[112:115], v[128:131]
    ds_read_b128 v[96:99], v45 offset:16384
    buffer_load_dwordx4 v2, s[36:39], s54 offen sc1 lds
    v_mfma_f32_16x16x32_bf16 v[144:147], a[28:31], v[112:115], v[144:147]
    s_add_u32 m0, m0, 4096
    s_add_u32 s54, s54, 4096
    v_mfma_f32_16x16x32_bf16 v[132:135], a[24:27], v[116:119], v[132:135]
    ds_read_b128 v[100:103], v46 offset:16384
    v_mfma_f32_16x16x32_bf16 v[148:151], a[28:31], v[116:119], v[148:151]
    v_mfma_f32_16x16x32_bf16 v[120:123], a[36:39], v[72:75], v[120:123]
    s_waitcnt vmcnt(6)
    s_barrier
    ds_read_b128 v[104:107], v43 offset:20480
    buffer_load_dwordx4 v2, s[36:39], s54 offen sc1 lds
    v_mfma_f32_16x16x32_bf16 v[136:139], a[40:43], v[72:75], v[136:139]
    s_add_u32 m0, m0, 4096
    s_add_u32 s54, s54, 4096
    v_mfma_f32_16x16x32_bf16 v[152:155], a[44:47], v[72:75], v[152:155]
    v_mfma_f32_16x16x32_bf16 v[124:127], a[36:39], v[76:79], v[124:127]
    ds_read_b128 v[108:111], v44 offset:20480
    v_mfma_f32_16x16x32_bf16 v[140:143], a[40:43], v[76:79], v[140:143]
    buffer_load_dwordx4 v2, s[36:39], s54 offen sc1 lds
    s_waitcnt lgkmcnt(4)
    v_mfma_f32_16x16x32_bf16 v[128:131], a[36:39], v[80:83], v[128:131]
    s_add_u32 m0, m0, 4096
    ds_read_b128 v[112:115], v45 offset:20480
    s_add_u32 s54, s54, 4096
    v_mfma_f32_16x16x32_bf16 v[144:147], a[40:43], v[80:83], v[144:147]
    v_mfma_f32_16x16x32_bf16 v[132:135], a[36:39], v[84:87], v[132:135]
    ds_read_b128 v[116:119], v46 offset:20480
    v_mfma_f32_16x16x32_bf16 v[148:151], a[40:43], v[84:87], v[148:151]
    buffer_load_dwordx4 v2, s[36:39], s54 offen sc1 lds
    s_add_u32 m0, m0, 4096
    v_mfma_f32_16x16x32_bf16 v[120:123], a[48:51], v[88:91], v[120:123]
    s_add_u32 s54, s54, 4096
    ds_read_b128 v[72:75], v43 offset:24576
    v_mfma_f32_16x16x32_bf16 v[136:139], a[52:55], v[88:91], v[136:139]
    v_mfma_f32_16x16x32_bf16 v[152:155], a[56:59], v[88:91], v[152:155]
    v_mfma_f32_16x16x32_bf16 v[124:127], a[48:51], v[92:95], v[124:127]
    ds_read_b128 v[76:79], v44 offset:24576
    buffer_load_dwordx4 v2, s[36:39], s54 offen sc1 lds
    v_mfma_f32_16x16x32_bf16 v[140:143], a[52:55], v[92:95], v[140:143]
    s_waitcnt lgkmcnt(4)
    v_mfma_f32_16x16x32_bf16 v[128:131], a[48:51], v[96:99], v[128:131]
    ds_read_b128 v[80:83], v45 offset:24576
    v_mfma_f32_16x16x32_bf16 v[144:147], a[52:55], v[96:99], v[144:147]
    v_mfma_f32_16x16x32_bf16 v[132:135], a[48:51], v[100:103], v[132:135]
    ds_read_b128 v[84:87], v46 offset:24576
    buffer_load_dwordx4 v[200:203], v14, s[36:39], s78 offen sc1
    v_mfma_f32_16x16x32_bf16 v[148:151], a[52:55], v[100:103], v[148:151]
    v_mfma_f32_16x16x32_bf16 v[120:123], a[60:63], v[104:107], v[120:123]
    ds_read_b128 v[88:91], v43 offset:28672
    v_mfma_f32_16x16x32_bf16 v[136:139], a[64:67], v[104:107], v[136:139]
    v_mfma_f32_16x16x32_bf16 v[152:155], a[68:71], v[104:107], v[152:155]
    buffer_load_dwordx4 v[204:207], v14, s[36:39], s78 offen offset:2048 sc1
    v_mfma_f32_16x16x32_bf16 v[124:127], a[60:63], v[108:111], v[124:127]
    ds_read_b128 v[92:95], v44 offset:28672
    v_mfma_f32_16x16x32_bf16 v[140:143], a[64:67], v[108:111], v[140:143]
    s_waitcnt lgkmcnt(4)
    v_mfma_f32_16x16x32_bf16 v[128:131], a[60:63], v[112:115], v[128:131]
    ds_read_b128 v[96:99], v45 offset:28672
    v_mfma_f32_16x16x32_bf16 v[144:147], a[64:67], v[112:115], v[144:147]
    buffer_load_dwordx4 v[208:211], v15, s[36:39], s78 offen sc1
    s_add_u32 m0, s67, 73728
    v_mfma_f32_16x16x32_bf16 v[132:135], a[60:63], v[116:119], v[132:135]
    s_add_u32 s54, s71, 0
    ds_read_b128 v[100:103], v46 offset:28672
    v_mfma_f32_16x16x32_bf16 v[148:151], a[64:67], v[116:119], v[148:151]
    v_mfma_f32_16x16x32_bf16 v[120:123], a[72:75], v[72:75], v[120:123]
    s_waitcnt vmcnt(9)
    s_barrier
    ds_read_b128 v[104:107], v43 offset:32768
    v_mfma_f32_16x16x32_bf16 v[136:139], a[76:79], v[72:75], v[136:139]
    s_mov_b32 exec_hi, 0
    buffer_load_dwordx4 v32, s[24:27], s54 offen lds
    s_mov_b32 exec_hi, -1
    v_mfma_f32_16x16x32_bf16 v[152:155], a[80:83], v[72:75], v[152:155]
    v_mfma_f32_16x16x32_bf16 v[124:127], a[72:75], v[76:79], v[124:127]
    ds_read_b128 v[108:111], v44 offset:32768
    v_mfma_f32_16x16x32_bf16 v[140:143], a[76:79], v[76:79], v[140:143]
    s_waitcnt lgkmcnt(4)
    v_mfma_f32_16x16x32_bf16 v[128:131], a[72:75], v[80:83], v[128:131]
    ds_read_b128 v[112:115], v45 offset:32768
    buffer_load_dwordx4 v33, s[24:27], s54 offen offset:512 lds
    v_mfma_f32_16x16x32_bf16 v[144:147], a[76:79], v[80:83], v[144:147]
    v_mfma_f32_16x16x32_bf16 v[132:135], a[72:75], v[84:87], v[132:135]
    ds_read_b128 v[116:119], v46 offset:32768
    v_mfma_f32_16x16x32_bf16 v[148:151], a[76:79], v[84:87], v[148:151]
    v_mfma_f32_16x16x32_bf16 v[120:123], a[84:87], v[88:91], v[120:123]
    ds_read_b128 v[72:75], v43 offset:36864
    v_mfma_f32_16x16x32_bf16 v[136:139], a[88:91], v[88:91], v[136:139]
    v_mfma_f32_16x16x32_bf16 v[152:155], a[92:95], v[88:91], v[152:155]
    buffer_load_dwordx4 v34, s[24:27], s54 offen offset:1536 lds
    v_mfma_f32_16x16x32_bf16 v[124:127], a[84:87], v[92:95], v[124:127]
    ds_read_b128 v[76:79], v44 offset:36864
    v_mfma_f32_16x16x32_bf16 v[140:143], a[88:91], v[92:95], v[140:143]
    s_waitcnt lgkmcnt(4)
    v_mfma_f32_16x16x32_bf16 v[128:131], a[84:87], v[96:99], v[128:131]
    ds_read_b128 v[80:83], v45 offset:36864
    v_mfma_f32_16x16x32_bf16 v[144:147], a[88:91], v[96:99], v[144:147]
    v_mfma_f32_16x16x32_bf16 v[132:135], a[84:87], v[100:103], v[132:135]
    ds_read_b128 v[84:87], v46 offset:36864
    v_mfma_f32_16x16x32_bf16 v[148:151], a[88:91], v[100:103], v[148:151]
    buffer_load_dwordx4 v35, s[24:27], s54 offen offset:2560 lds
    v_mfma_f32_16x16x32_bf16 v[120:123], a[96:99], v[104:107], v[120:123]
    ds_read_b128 v[88:91], v43 offset:40960
    v_mfma_f32_16x16x32_bf16 v[136:139], a[100:103], v[104:107], v[136:139]
    v_mfma_f32_16x16x32_bf16 v[152:155], a[104:107], v[104:107], v[152:155]
    v_mfma_f32_16x16x32_bf16 v[124:127], a[96:99], v[108:111], v[124:127]
    ds_read_b128 v[92:95], v44 offset:40960
    v_mfma_f32_16x16x32_bf16 v[140:143], a[100:103], v[108:111], v[140:143]
    s_waitcnt lgkmcnt(4)
    v_mfma_f32_16x16x32_bf16 v[128:131], a[96:99], v[112:115], v[128:131]
    ds_read_b128 v[96:99], v45 offset:40960
    buffer_load_dwordx4 v36, s[24:27], s54 offen offset:3584 lds
    v_mfma_f32_16x16x32_bf16 v[144:147], a[100:103], v[112:115], v[144:147]
    s_add_u32 m0, s67, 92160
    s_add_u32 s54, s71, 73728
    v_mfma_f32_16x16x32_bf16 v[132:135], a[96:99], v[116:119], v[132:135]
    ds_read_b128 v[100:103], v46 offset:40960
    v_mfma_f32_16x16x32_bf16 v[148:151], a[100:103], v[116:119], v[148:151]
    v_mfma_f32_16x16x32_bf16 v[120:123], a[108:111], v[72:75], v[120:123]
    ds_read_b128 v[104:107], v43 offset:45056
    v_mfma_f32_16x16x32_bf16 v[136:139], a[112:115], v[72:75], v[136:139]
    v_mfma_f32_16x16x32_bf16 v[152:155], a[116:119], v[72:75], v[152:155]
    s_mov_b32 exec_hi, 0
    buffer_load_dwordx4 v32, s[24:27], s54 offen lds
    s_mov_b32 exec_hi, -1
    v_mfma_f32_16x16x32_bf16 v[124:127], a[108:111], v[76:79], v[124:127]
    ds_read_b128 v[108:111], v44 offset:45056
    v_mfma_f32_16x16x32_bf16 v[140:143], a[112:115], v[76:79], v[140:143]
    s_waitcnt lgkmcnt(4)
    v_mfma_f32_16x16x32_bf16 v[128:131], a[108:111], v[80:83], v[128:131]
    ds_read_b128 v[112:115], v45 offset:45056
    v_mfma_f32_16x16x32_bf16 v[144:147], a[112:115], v[80:83], v[144:147]
    buffer_load_dwordx4 v33, s[24:27], s54 offen offset:512 lds
    v_mfma_f32_16x16x32_bf16 v[132:135], a[108:111], v[84:87], v[132:135]
    ds_read_b128 v[116:119], v46 offset:45056
    v_mfma_f32_16x16x32_bf16 v[148:151], a[112:115], v[84:87], v[148:151]
    v_mfma_f32_16x16x32_bf16 v[120:123], a[120:123], v[88:91], v[120:123]
    s_waitcnt vmcnt(10)
    s_barrier
    ds_read_b128 v[72:75], v43 offset:49152
    v_mfma_f32_16x16x32_bf16 v[136:139], a[124:127], v[88:91], v[136:139]
    v_mfma_f32_16x16x32_bf16 v[152:155], a[128:131], v[88:91], v[152:155]
    v_mfma_f32_16x16x32_bf16 v[124:127], a[120:123], v[92:95], v[124:127]
    ds_read_b128 v[76:79], v44 offset:49152
    buffer_load_dwordx4 v34, s[24:27], s54 offen offset:1536 lds
    v_mfma_f32_16x16x32_bf16 v[140:143], a[124:127], v[92:95], v[140:143]
    s_waitcnt lgkmcnt(4)
    v_mfma_f32_16x16x32_bf16 v[128:131], a[120:123], v[96:99], v[128:131]
    ds_read_b128 v[80:83], v45 offset:49152
    v_mfma_f32_16x16x32_bf16 v[144:147], a[124:127], v[96:99], v[144:147]
    v_mfma_f32_16x16x32_bf16 v[132:135], a[120:123], v[100:103], v[132:135]
    ds_read_b128 v[84:87], v46 offset:49152
    v_mfma_f32_16x16x32_bf16 v[148:151], a[124:127], v[100:103], v[148:151]
    v_mfma_f32_16x16x32_bf16 v[120:123], a[132:135], v[104:107], v[120:123]
    s_waitcnt vmcnt(8)
    ds_read_b128 v[88:91], v43 offset:53248
    buffer_load_dwordx4 v35, s[24:27], s54 offen offset:2560 lds
    v_mfma_f32_16x16x32_bf16 v[136:139], a[136:139], v[104:107], v[136:139]
    v_xor_b32 v16, s48, v200
    v_xor_b32 v9, s48, v203
    v_mfma_f32_16x16x32_bf16 v[152:155], a[140:143], v[104:107], v[152:155]
    v_or_b32 v16, v16, v9
    v_xor_b32 v9, s48, v204
    v_mfma_f32_16x16x32_bf16 v[124:127], a[132:135], v[108:111], v[124:127]
    ds_read_b128 v[92:95], v44 offset:53248
    v_or_b32 v16, v16, v9
    v_mfma_f32_16x16x32_bf16 v[140:143], a[136:139], v[108:111], v[140:143]
    v_xor_b32 v9, s48, v207
    s_waitcnt lgkmcnt(4)
    v_mfma_f32_16x16x32_bf16 v[128:131], a[132:135], v[112:115], v[128:131]
    ds_read_b128 v[96:99], v45 offset:53248
    v_or_b32 v16, v16, v9
    v_mfma_f32_16x16x32_bf16 v[144:147], a[136:139], v[112:115], v[144:147]
    buffer_load_dwordx4 v36, s[24:27], s54 offen offset:3584 lds
    s_add_u32 m0, s67, 110592
    v_mfma_f32_16x16x32_bf16 v[132:135], a[132:135], v[116:119], v[132:135]
    s_add_u32 s54, s88, 0
    ds_read_b128 v[100:103], v46 offset:53248
    v_xor_b32 v9, s48, v208
    v_mfma_f32_16x16x32_bf16 v[148:151], a[136:139], v[116:119], v[148:151]
    v_or_b32 v16, v16, v9
    v_xor_b32 v9, s48, v211
    v_mfma_f32_16x16x32_bf16 v[120:123], a[144:147], v[72:75], v[120:123]
    ds_read_b128 v[104:107], v43 offset:57344
    v_or_b32 v16, v16, v9
    v_mfma_f32_16x16x32_bf16 v[136:139], a[148:151], v[72:75], v[136:139]
    v_add_f32 v168, v201, v205
    v_add_f32 v169, v202, v206
    v_mfma_f32_16x16x32_bf16 v[152:155], a[152:155], v[72:75], v[152:155]
    v_mov_b32 v170, v168
    v_mov_b32 v171, v169
    v_mfma_f32_16x16x32_bf16 v[124:127], a[144:147], v[76:79], v[124:127]
    ds_read_b128 v[108:111], v44 offset:57344
    v_permlane32_swap_b32 v168, v170
    v_mfma_f32_16x16x32_bf16 v[140:143], a[148:151], v[76:79], v[140:143]
    s_mov_b32 exec_hi, 0
    buffer_load_dwordx4 v32, s[24:27], s54 offen lds
    s_mov_b32 exec_hi, -1
    s_waitcnt lgkmcnt(4)
    v_mfma_f32_16x16x32_bf16 v[128:131], a[144:147], v[80:83], v[128:131]
    ds_read_b128 v[112:115], v45 offset:57344
    v_permlane32_swap_b32 v169, v171
    v_mfma_f32_16x16x32_bf16 v[144:147], a[148:151], v[80:83], v[144:147]
    v_add_f32 v168, v168, v170
    v_add_f32 v169, v169, v171
    v_mfma_f32_16x16x32_bf16 v[132:135], a[144:147], v[84:87], v[132:135]
    ds_read_b128 v[116:119], v46 offset:57344
    v_mov_b32 v170, v168
    v_mfma_f32_16x16x32_bf16 v[148:151], a[148:151], v[84:87], v[148:151]
    buffer_load_dwordx4 v33, s[24:27], s54 offen offset:512 lds
    v_mov_b32 v171, v169
    v_mfma_f32_16x16x32_bf16 v[120:123], a[156:159], v[88:91], v[120:123]
    ds_read_b128 v[72:75], v43 offset:61440
    v_permlane16_swap_b32 v168, v170
    v_mfma_f32_16x16x32_bf16 v[136:139], a[160:163], v[88:91], v[136:139]
    v_permlane16_swap_b32 v169, v171
    v_add_f32 v168, v168, v170
    v_mfma_f32_16x16x32_bf16 v[152:155], a[164:167], v[88:91], v[152:155]
    v_add_f32 v169, v169, v171
    v_add_f32 v168, v168, v209
    v_mfma_f32_16x16x32_bf16 v[124:127], a[156:159], v[92:95], v[124:127]
    ds_read_b128 v[76:79], v44 offset:61440
    v_add_f32 v169, v169, v210
    v_mfma_f32_16x16x32_bf16 v[140:143], a[160:163], v[92:95], v[140:143]
    v_mul_f32 v168, 0x3ae38e39, v168
    s_waitcnt lgkmcnt(4)
    v_mfma_f32_16x16x32_bf16 v[128:131], a[156:159], v[96:99], v[128:131]
    ds_read_b128 v[80:83], v45 offset:61440
    buffer_load_dwordx4 v34, s[24:27], s54 offen offset:1536 lds
    v_mfma_f32_16x16x32_bf16 v[144:147], a[160:163], v[96:99], v[144:147]
    v_mul_f32 v169, 0x3ae38e39, v169
    v_fma_f32 v169, -v168, v168, v169
    v_mfma_f32_16x16x32_bf16 v[132:135], a[156:159], v[100:103], v[132:135]
    ds_read_b128 v[84:87], v46 offset:61440
    v_max_f32 v169, 0, v169
    v_mfma_f32_16x16x32_bf16 v[148:151], a[160:163], v[100:103], v[148:151]
    v_cvt_pk_bf16_f32 v8, v168, v169
    v_lshlrev_b32 v168, 16, v8
    v_mfma_f32_16x16x32_bf16 v[120:123], a[168:171], v[104:107], v[120:123]
    s_waitcnt vmcnt(3)
    s_barrier
    ds_read_b128 v[88:91], v47 offset:0
    v_and_b32 v169, 0xffff0000, v8
    v_mfma_f32_16x16x32_bf16 v[136:139], a[172:175], v[104:107], v[136:139]
    ds_read_b64_tr_b16 a[0:1], v38 offset:18432
    v_add_f32 v169, 0x3727c5ac, v169
    v_mfma_f32_16x16x32_bf16 v[152:155], a[176:179], v[104:107], v[152:155]
    buffer_load_dwordx4 v35, s[24:27], s54 offen offset:2560 lds
    ds_read_b64_tr_b16 a[2:3], v38 offset:23040
    v_mfma_f32_16x16x32_bf16 v[124:127], a[168:171], v[108:111], v[124:127]
    ds_read_b128 v[92:95], v48 offset:0
    v_cvt_pk_bf16_f32 v8, v169, v169
    v_mfma_f32_16x16x32_bf16 v[140:143], a[172:175], v[108:111], v[140:143]
    ds_read_b64_tr_b16 a[4:5], v38 offset:18464
    s_waitcnt lgkmcnt(7)
    v_mfma_f32_16x16x32_bf16 v[128:131], a[168:171], v[112:115], v[128:131]
    ds_read_b128 v[96:99], v49 offset:0
    v_lshlrev_b32 v169, 16, v8
    v_mfma_f32_16x16x32_bf16 v[144:147], a[172:175], v[112:115], v[144:147]
    ds_read_b64_tr_b16 a[6:7], v38 offset:23072
    v_sqrt_f32 v169, v169
    v_mfma_f32_16x16x32_bf16 v[132:135], a[168:171], v[116:119], v[132:135]
    ds_read_b128 v[100:103], v50 offset:0
    v_cvt_pk_bf16_f32 v8, v169, v169
    v_mfma_f32_16x16x32_bf16 v[148:151], a[172:175], v[116:119], v[148:151]
    buffer_load_dwordx4 v36, s[24:27], s54 offen offset:3584 lds
    s_add_u32 m0, s67, 129024
    v_mfma_f32_16x16x32_bf16 v[120:123], a[180:183], v[72:75], v[120:123]
    s_add_u32 s54, s88, 73728
    ds_read_b128 v[104:107], v47 offset:4096
    v_lshlrev_b32 v169, 16, v8
    v_mfma_f32_16x16x32_bf16 v[136:139], a[184:187], v[72:75], v[136:139]
    ds_read_b64_tr_b16 a[8:9], v41 offset:18432
    v_rcp_f32 v8, v169
    v_mfma_f32_16x16x32_bf16 v[152:155], a[188:191], v[72:75], v[152:155]
    ds_read_b64_tr_b16 a[10:11], v41 offset:23040
    v_mul_f32 v169, -v168, v8
    v_mfma_f32_16x16x32_bf16 v[124:127], a[180:183], v[76:79], v[124:127]
    ds_read_b128 v[108:111], v48 offset:4096
    v_mov_b32 v168, v8
    v_mfma_f32_16x16x32_bf16 v[140:143], a[184:187], v[76:79], v[140:143]
    ds_read_b64_tr_b16 a[12:13], v38 offset:27648
    s_waitcnt lgkmcnt(9)
    v_mfma_f32_16x16x32_bf16 v[128:131], a[180:183], v[80:83], v[128:131]
    ds_read_b128 v[112:115], v49 offset:4096
    v_mfma_f32_16x16x32_bf16 v[144:147], a[184:187], v[80:83], v[144:147]
    s_mov_b32 exec_hi, 0
    buffer_load_dwordx4 v32, s[24:27], s54 offen lds
    s_mov_b32 exec_hi, -1
    v_mfma_f32_16x16x32_bf16 v[132:135], a[180:183], v[84:87], v[132:135]
    ds_read_b128 v[116:119], v50 offset:4096
    v_mfma_f32_16x16x32_bf16 v[148:151], a[184:187], v[84:87], v[148:151]
    ds_read_b64_tr_b16 a[14:15], v38 offset:32256
    v_mfma_f32_16x16x32_bf16 v[120:123], a[192:195], v[88:91], v[120:123]
    ds_read_b64_tr_b16 a[16:17], v38 offset:27680
    v_mfma_f32_16x16x32_bf16 v[136:139], a[196:199], v[88:91], v[136:139]
    buffer_load_dwordx4 v33, s[24:27], s54 offen offset:512 lds
    ds_read_b64_tr_b16 a[18:19], v38 offset:32288
    v_mfma_f32_16x16x32_bf16 v[152:155], a[200:203], v[88:91], v[152:155]
    ds_read_b64_tr_b16 a[20:21], v41 offset:27648
    v_mfma_f32_16x16x32_bf16 v[124:127], a[192:195], v[92:95], v[124:127]
    ds_read_b64_tr_b16 a[22:23], v41 offset:32256
    v_mfma_f32_16x16x32_bf16 v[140:143], a[196:199], v[92:95], v[140:143]
    ds_read_b64_tr_b16 a[24:25], v38 offset:36864
    s_waitcnt lgkmcnt(9)
    v_mfma_f32_16x16x32_bf16 v[128:131], a[192:195], v[96:99], v[128:131]
    ds_read_b64_tr_b16 a[26:27], v38 offset:41472
    v_mfma_f32_16x16x32_bf16 v[144:147], a[196:199], v[96:99], v[144:147]
    ds_read_b64_tr_b16 a[28:29], v38 offset:36896
    v_mfma_f32_16x16x32_bf16 v[132:135], a[192:195], v[100:103], v[132:135]
    buffer_load_dwordx4 v34, s[24:27], s54 offen offset:1536 lds
    ds_read_b64_tr_b16 a[30:31], v38 offset:41504
    v_mfma_f32_16x16x32_bf16 v[148:151], a[196:199], v[100:103], v[148:151]
    ds_read_b64_tr_b16 a[32:33], v41 offset:36864
    v_mfma_f32_16x16x32_bf16 v[120:123], a[204:207], v[104:107], v[120:123]
    ds_read_b64_tr_b16 a[34:35], v41 offset:41472
    v_mfma_f32_16x16x32_bf16 v[136:139], a[208:211], v[104:107], v[136:139]
    ds_read_b64_tr_b16 a[36:37], v38 offset:46080
    v_mfma_f32_16x16x32_bf16 v[152:155], a[212:215], v[104:107], v[152:155]
    ds_read_b64_tr_b16 a[38:39], v38 offset:50688
    v_mfma_f32_16x16x32_bf16 v[124:127], a[204:207], v[108:111], v[124:127]
    ds_read_b64_tr_b16 a[40:41], v38 offset:46112
    v_mfma_f32_16x16x32_bf16 v[140:143], a[208:211], v[108:111], v[140:143]
    buffer_load_dwordx4 v35, s[24:27], s54 offen offset:2560 lds
    s_waitcnt lgkmcnt(14)
    v_mfma_f32_16x16x32_bf16 v[128:131], a[204:207], v[112:115], v[128:131]
    ds_read_b64_tr_b16 a[42:43], v38 offset:50720
    v_mfma_f32_16x16x32_bf16 v[144:147], a[208:211], v[112:115], v[144:147]
    ds_read_b64_tr_b16 a[44:45], v41 offset:46080
    v_mfma_f32_16x16x32_bf16 v[132:135], a[204:207], v[116:119], v[132:135]
    ds_read_b64_tr_b16 a[46:47], v41 offset:50688
    v_mfma_f32_16x16x32_bf16 v[148:151], a[208:211], v[116:119], v[148:151]
    buffer_load_dwordx4 v36, s[24:27], s54 offen offset:3584 lds
    buffer_load_dword v18, v10, s[36:39], s80 offen
    v_cmp_ne_u32 vcc, 0, v16
    s_nop 4
    s_cbranch_vccnz recslow_7
recdone_8:
    ds_write_b64 v55, v[168:169]
    ds_read_b64 v[240:241], v51
    ds_read_b32 v242, v52
    s_waitcnt lgkmcnt(0)
    s_barrier
    ds_read_b64 v[170:171], v56
    ds_read_b64 v[172:173], v57
    ds_read_b64 v[174:175], v58
    s_add_u32 m0, s67, 73728
    s_add_u32 s54, s89, 0
    s_mov_b32 exec_hi, 0
    buffer_load_dwordx4 v32, s[24:27], s54 offen lds
    s_mov_b32 exec_hi, -1
    v_pk_mul_f32 v[152:153], v[152:153], v[168:169] op_sel_hi:[1,0]
    v_pk_mul_f32 v[154:155], v[154:155], v[168:169] op_sel_hi:[1,0]
    v_pk_fma_f32 v[152:153], v[164:165], v[168:169], v[152:153] op_sel:[0,1,0]
    v_pk_fma_f32 v[154:155], v[166:167], v[168:169], v[154:155] op_sel:[0,1,0]
    v_pk_mul_f32 v[72:73], v[152:153], v[152:153]
    v_pk_mul_f32 v[74:75], v[154:155], v[154:155]
    v_pk_fma_f32 v[72:73], v[72:73], s[72:73], v[4:5]
    v_pk_fma_f32 v[74:75], v[74:75], s[72:73], v[4:5]
    v_pk_mul_f32 v[72:73], v[72:73], v[152:153]
    v_pk_mul_f32 v[74:75], v[74:75], v[154:155]
    v_exp_f32 v72, v72
    v_exp_f32 v73, v73
    v_exp_f32 v74, v74
    v_exp_f32 v75, v75
    v_pk_add_f32 v[72:73], v[72:73], 1.0 op_sel_hi:[1,0]
    v_pk_add_f32 v[74:75], v[74:75], 1.0 op_sel_hi:[1,0]
    v_rcp_f32 v72, v72
    v_rcp_f32 v73, v73
    v_rcp_f32 v74, v74
    v_rcp_f32 v75, v75
    v_pk_mul_f32 v[152:153], v[152:153], v[72:73]
    v_pk_mul_f32 v[154:155], v[154:155], v[74:75]
    v_cvt_pk_bf16_f32 v192, v152, v153
    v_cvt_pk_bf16_f32 v193, v154, v155
    buffer_store_dwordx2 v[192:193], v47, s[36:39], s83 offen
    buffer_load_dwordx4 v33, s[24:27], s54 offen offset:512 lds
    v_pk_mul_f32 v[120:121], v[120:121], v[168:169] op_sel_hi:[1,0]
    v_pk_mul_f32 v[122:123], v[122:123], v[168:169] op_sel_hi:[1,0]
    v_pk_fma_f32 v[120:121], v[156:157], v[168:169], v[120:121] op_sel:[0,1,0]
    v_pk_fma_f32 v[122:123], v[158:159], v[168:169], v[122:123] op_sel:[0,1,0]
    v_pk_mul_f32 v[136:137], v[136:137], v[168:169] op_sel_hi:[1,0]
    v_pk_mul_f32 v[138:139], v[138:139], v[168:169] op_sel_hi:[1,0]
    v_pk_fma_f32 v[136:137], v[160:161], v[168:169], v[136:137] op_sel:[0,1,0]
    v_pk_fma_f32 v[138:139], v[162:163], v[168:169], v[138:139] op_sel:[0,1,0]
    v_pk_mul_f32 v[72:73], v[120:121], v[120:121]
    v_pk_mul_f32 v[74:75], v[122:123], v[122:123]
    v_pk_mul_f32 v[76:77], v[136:137], v[136:137]
    v_pk_mul_f32 v[78:79], v[138:139], v[138:139]
    v_pk_fma_f32 v[72:73], v[72:73], s[72:73], v[4:5]
    v_pk_fma_f32 v[74:75], v[74:75], s[72:73], v[4:5]
    v_pk_fma_f32 v[76:77], v[76:77], s[72:73], v[4:5]
    v_pk_fma_f32 v[78:79], v[78:79], s[72:73], v[4:5]
    v_pk_mul_f32 v[72:73], v[72:73], v[120:121]
    v_pk_mul_f32 v[74:75], v[74:75], v[122:123]
    v_pk_mul_f32 v[76:77], v[76:77], v[136:137]
    v_pk_mul_f32 v[78:79], v[78:79], v[138:139]
    v_exp_f32 v72, v72
    v_exp_f32 v73, v73
    v_exp_f32 v74, v74
    v_exp_f32 v75, v75
    v_exp_f32 v76, v76
    v_exp_f32 v77, v77
    v_exp_f32 v78, v78
    v_exp_f32 v79, v79
    v_pk_add_f32 v[72:73], v[72:73], 1.0 op_sel_hi:[1,0]
    v_pk_add_f32 v[74:75], v[74:75], 1.0 op_sel_hi:[1,0]
    v_pk_add_f32 v[76:77], v[76:77], 1.0 op_sel_hi:[1,0]
    v_pk_add_f32 v[78:79], v[78:79], 1.0 op_sel_hi:[1,0]
    v_rcp_f32 v72, v72
    v_rcp_f32 v73, v73
    v_rcp_f32 v74, v74
    v_rcp_f32 v75, v75
    v_rcp_f32 v76, v76
    v_rcp_f32 v77, v77
    v_rcp_f32 v78, v78
    v_rcp_f32 v79, v79
    v_pk_mul_f32 v[120:121], v[120:121], v[72:73]
    v_pk_mul_f32 v[122:123], v[122:123], v[74:75]
    v_pk_mul_f32 v[136:137], v[136:137], v[76:77]
    v_pk_mul_f32 v[138:139], v[138:139], v[78:79]
    v_cvt_pk_bf16_f32 v176, v120, v121
    v_cvt_pk_bf16_f32 v177, v122, v123
    v_cvt_pk_bf16_f32 v178, v136, v137
    v_cvt_pk_bf16_f32 v179, v138, v139
    buffer_store_dwordx4 v[176:179], v43, s[36:39], s81 offen
    ds_write_b128 v64, v[176:179]
    buffer_load_dwordx4 v34, s[24:27], s54 offen offset:1536 lds
    s_waitcnt lgkmcnt(1)
    v_pk_mul_f32 v[124:125], v[124:125], v[170:171] op_sel_hi:[1,0]
    v_pk_mul_f32 v[126:127], v[126:127], v[170:171] op_sel_hi:[1,0]
    v_pk_fma_f32 v[124:125], v[156:157], v[170:171], v[124:125] op_sel:[0,1,0]
    v_pk_fma_f32 v[126:127], v[158:159], v[170:171], v[126:127] op_sel:[0,1,0]
    v_pk_mul_f32 v[140:141], v[140:141], v[170:171] op_sel_hi:[1,0]
    v_pk_mul_f32 v[142:143], v[142:143], v[170:171] op_sel_hi:[1,0]
    v_pk_fma_f32 v[140:141], v[160:161], v[170:171], v[140:141] op_sel:[0,1,0]
    v_pk_fma_f32 v[142:143], v[162:163], v[170:171], v[142:143] op_sel:[0,1,0]
    v_pk_mul_f32 v[72:73], v[124:125], v[124:125]
    v_pk_mul_f32 v[74:75], v[126:127], v[126:127]
    v_pk_mul_f32 v[76:77], v[140:141], v[140:141]
    v_pk_mul_f32 v[78:79], v[142:143], v[142:143]
    v_pk_fma_f32 v[72:73], v[72:73], s[72:73], v[4:5]
    v_pk_fma_f32 v[74:75], v[74:75], s[72:73], v[4:5]
    v_pk_fma_f32 v[76:77], v[76:77], s[72:73], v[4:5]
    v_pk_fma_f32 v[78:79], v[78:79], s[72:73], v[4:5]
    v_pk_mul_f32 v[72:73], v[72:73], v[124:125]
    v_pk_mul_f32 v[74:75], v[74:75], v[126:127]
    v_pk_mul_f32 v[76:77], v[76:77], v[140:141]
    v_pk_mul_f32 v[78:79], v[78:79], v[142:143]
    v_exp_f32 v72, v72
    v_exp_f32 v73, v73
    v_exp_f32 v74, v74
    v_exp_f32 v75, v75
    v_exp_f32 v76, v76
    v_exp_f32 v77, v77
    v_exp_f32 v78, v78
    v_exp_f32 v79, v79
    v_pk_add_f32 v[72:73], v[72:73], 1.0 op_sel_hi:[1,0]
    v_pk_add_f32 v[74:75], v[74:75], 1.0 op_sel_hi:[1,0]
    v_pk_add_f32 v[76:77], v[76:77], 1.0 op_sel_hi:[1,0]
    v_pk_add_f32 v[78:79], v[78:79], 1.0 op_sel_hi:[1,0]
    v_rcp_f32 v72, v72
    v_rcp_f32 v73, v73
    v_rcp_f32 v74, v74
    v_rcp_f32 v75, v75
    v_rcp_f32 v76, v76
    v_rcp_f32 v77, v77
    v_rcp_f32 v78, v78
    v_rcp_f32 v79, v79
    v_pk_mul_f32 v[124:125], v[124:125], v[72:73]
    v_pk_mul_f32 v[126:127], v[126:127], v[74:75]
    v_pk_mul_f32 v[140:141], v[140:141], v[76:77]
    v_pk_mul_f32 v[142:143], v[142:143], v[78:79]
    v_cvt_pk_bf16_f32 v180, v124, v125
    v_cvt_pk_bf16_f32 v181, v126, v127
    v_cvt_pk_bf16_f32 v182, v140, v141
    v_cvt_pk_bf16_f32 v183, v142, v143
    buffer_store_dwordx4 v[180:183], v44, s[36:39], s81 offen
    ds_write_b128 v65, v[180:183]
    buffer_load_dwordx4 v35, s[24:27], s54 offen offset:2560 lds
    v_pk_mul_f32 v[128:129], v[128:129], v[172:173] op_sel_hi:[1,0]
    v_pk_mul_f32 v[130:131], v[130:131], v[172:173] op_sel_hi:[1,0]
    v_pk_fma_f32 v[128:129], v[156:157], v[172:173], v[128:129] op_sel:[0,1,0]
    v_pk_fma_f32 v[130:131], v[158:159], v[172:173], v[130:131] op_sel:[0,1,0]
    v_pk_mul_f32 v[144:145], v[144:145], v[172:173] op_sel_hi:[1,0]
    v_pk_mul_f32 v[146:147], v[146:147], v[172:173] op_sel_hi:[1,0]
    v_pk_fma_f32 v[144:145], v[160:161], v[172:173], v[144:145] op_sel:[0,1,0]
    v_pk_fma_f32 v[146:147], v[162:163], v[172:173], v[146:147] op_sel:[0,1,0]
    v_pk_mul_f32 v[72:73], v[128:129], v[128:129]
    v_pk_mul_f32 v[74:75], v[130:131], v[130:131]
    v_pk_mul_f32 v[76:77], v[144:145], v[144:145]
    v_pk_mul_f32 v[78:79], v[146:147], v[146:147]
    v_pk_fma_f32 v[72:73], v[72:73], s[72:73], v[4:5]
    v_pk_fma_f32 v[74:75], v[74:75], s[72:73], v[4:5]
    v_pk_fma_f32 v[76:77], v[76:77], s[72:73], v[4:5]
    v_pk_fma_f32 v[78:79], v[78:79], s[72:73], v[4:5]
    v_pk_mul_f32 v[72:73], v[72:73], v[128:129]
    v_pk_mul_f32 v[74:75], v[74:75], v[130:131]
    v_pk_mul_f32 v[76:77], v[76:77], v[144:145]
    v_pk_mul_f32 v[78:79], v[78:79], v[146:147]
    v_exp_f32 v72, v72
    v_exp_f32 v73, v73
    v_exp_f32 v74, v74
    v_exp_f32 v75, v75
    v_exp_f32 v76, v76
    v_exp_f32 v77, v77
    v_exp_f32 v78, v78
    v_exp_f32 v79, v79
    v_pk_add_f32 v[72:73], v[72:73], 1.0 op_sel_hi:[1,0]
    v_pk_add_f32 v[74:75], v[74:75], 1.0 op_sel_hi:[1,0]
    v_pk_add_f32 v[76:77], v[76:77], 1.0 op_sel_hi:[1,0]
    v_pk_add_f32 v[78:79], v[78:79], 1.0 op_sel_hi:[1,0]
    v_rcp_f32 v72, v72
    v_rcp_f32 v73, v73
    v_rcp_f32 v74, v74
    v_rcp_f32 v75, v75
    v_rcp_f32 v76, v76
    v_rcp_f32 v77, v77
    v_rcp_f32 v78, v78
    v_rcp_f32 v79, v79
    v_pk_mul_f32 v[128:129], v[128:129], v[72:73]
    v_pk_mul_f32 v[130:131], v[130:131], v[74:75]
    v_pk_mul_f32 v[144:145], v[144:145], v[76:77]
    v_pk_mul_f32 v[146:147], v[146:147], v[78:79]
    v_cvt_pk_bf16_f32 v184, v128, v129
    v_cvt_pk_bf16_f32 v185, v130, v131
    v_cvt_pk_bf16_f32 v186, v144, v145
    v_cvt_pk_bf16_f32 v187, v146, v147
    buffer_store_dwordx4 v[184:187], v45, s[36:39], s81 offen
    ds_write_b128 v66, v[184:187]
    buffer_load_dwordx4 v36, s[24:27], s54 offen offset:3584 lds
    v_pk_mul_f32 v[132:133], v[132:133], v[174:175] op_sel_hi:[1,0]
    v_pk_mul_f32 v[134:135], v[134:135], v[174:175] op_sel_hi:[1,0]
    v_pk_fma_f32 v[132:133], v[156:157], v[174:175], v[132:133] op_sel:[0,1,0]
    v_pk_fma_f32 v[134:135], v[158:159], v[174:175], v[134:135] op_sel:[0,1,0]
    v_pk_mul_f32 v[148:149], v[148:149], v[174:175] op_sel_hi:[1,0]
    v_pk_mul_f32 v[150:151], v[150:151], v[174:175] op_sel_hi:[1,0]
    v_pk_fma_f32 v[148:149], v[160:161], v[174:175], v[148:149] op_sel:[0,1,0]
    v_pk_fma_f32 v[150:151], v[162:163], v[174:175], v[150:151] op_sel:[0,1,0]
    v_pk_mul_f32 v[72:73], v[132:133], v[132:133]
    v_pk_mul_f32 v[74:75], v[134:135], v[134:135]
    v_pk_mul_f32 v[76:77], v[148:149], v[148:149]
    v_pk_mul_f32 v[78:79], v[150:151], v[150:151]
    v_pk_fma_f32 v[72:73], v[72:73], s[72:73], v[4:5]
    v_pk_fma_f32 v[74:75], v[74:75], s[72:73], v[4:5]
    v_pk_fma_f32 v[76:77], v[76:77], s[72:73], v[4:5]
    v_pk_fma_f32 v[78:79], v[78:79], s[72:73], v[4:5]
    v_pk_mul_f32 v[72:73], v[72:73], v[132:133]
    v_pk_mul_f32 v[74:75], v[74:75], v[134:135]
    v_pk_mul_f32 v[76:77], v[76:77], v[148:149]
    v_pk_mul_f32 v[78:79], v[78:79], v[150:151]
    v_exp_f32 v72, v72
    v_exp_f32 v73, v73
    v_exp_f32 v74, v74
    v_exp_f32 v75, v75
    v_exp_f32 v76, v76
    v_exp_f32 v77, v77
    v_exp_f32 v78, v78
    v_exp_f32 v79, v79
    v_pk_add_f32 v[72:73], v[72:73], 1.0 op_sel_hi:[1,0]
    v_pk_add_f32 v[74:75], v[74:75], 1.0 op_sel_hi:[1,0]
    v_pk_add_f32 v[76:77], v[76:77], 1.0 op_sel_hi:[1,0]
    v_pk_add_f32 v[78:79], v[78:79], 1.0 op_sel_hi:[1,0]
    v_rcp_f32 v72, v72
    v_rcp_f32 v73, v73
    v_rcp_f32 v74, v74
    v_rcp_f32 v75, v75
    v_rcp_f32 v76, v76
    v_rcp_f32 v77, v77
    v_rcp_f32 v78, v78
    v_rcp_f32 v79, v79
    v_pk_mul_f32 v[132:133], v[132:133], v[72:73]
    v_pk_mul_f32 v[134:135], v[134:135], v[74:75]
    v_pk_mul_f32 v[148:149], v[148:149], v[76:77]
    v_pk_mul_f32 v[150:151], v[150:151], v[78:79]
    v_cvt_pk_bf16_f32 v188, v132, v133
    v_cvt_pk_bf16_f32 v189, v134, v135
    v_cvt_pk_bf16_f32 v190, v148, v149
    v_cvt_pk_bf16_f32 v191, v150, v151
    buffer_store_dwordx4 v[188:191], v46, s[36:39], s81 offen
    ds_write_b128 v67, v[188:191]
    s_add_u32 m0, s67, 92160
    s_add_u32 s54, s89, 73728
    s_mov_b32 exec_hi, 0
    buffer_load_dwordx4 v32, s[24:27], s54 offen lds
    s_mov_b32 exec_hi, -1
    buffer_load_dwordx4 v33, s[24:27], s54 offen offset:512 lds
    buffer_load_dwordx4 v34, s[24:27], s54 offen offset:1536 lds
    buffer_load_dwordx4 v35, s[24:27], s54 offen offset:2560 lds
    buffer_load_dwordx4 v36, s[24:27], s54 offen offset:3584 lds
    s_lshl_b32 s52, s42, 5
    s_add_u32 s52, s52, s40
    s_lshl_b32 s58, s42, 15
    s_lshl_b32 s51, s40, 9
    s_add_u32 s58, s58, s51
    s_add_u32 s58, s58, 6528
    s_or_b32 s50, s47, 0x30
    v_mov_b32 v6, s50
    v_mov_b32 v7, s57
    s_waitcnt lgkmcnt(0)
    s_waitcnt vmcnt(16)
    s_barrier
    ds_read_b128 v[72:75], v43 offset:0
    ds_read_b128 v[76:79], v44 offset:0
    ds_read_b128 v[80:83], v45 offset:0
    ds_read_b128 v[84:87], v46 offset:0
    ds_read_b128 v[88:91], v43 offset:4096
    ds_read_b128 v[92:95], v44 offset:4096
    ds_read_b128 v[96:99], v45 offset:4096
    ds_read_b128 v[100:103], v46 offset:4096
    s_waitcnt lgkmcnt(6)
    v_mfma_f32_16x16x32_bf16 v[120:123], a[0:3], v[72:75], 0
    s_add_u32 m0, s67, 55296
    ds_read_b128 v[104:107], v43 offset:8192
    s_add_u32 s54, s3, 0
    v_mfma_f32_16x16x32_bf16 v[136:139], a[4:7], v[72:75], 0
    ds_read_b64_tr_b16 a[48:49], v39 offset:0
    v_mfma_f32_16x16x32_bf16 v[152:155], a[8:11], v[72:75], 0
    ds_read_b64_tr_b16 a[50:51], v39 offset:4608
    v_mfma_f32_16x16x32_bf16 v[124:127], a[0:3], v[76:79], 0
    ds_read_b128 v[108:111], v44 offset:8192
    v_mfma_f32_16x16x32_bf16 v[140:143], a[4:7], v[76:79], 0
    s_mov_b32 exec_hi, 0
    buffer_load_dwordx4 v32, s[24:27], s54 offen lds
    s_mov_b32 exec_hi, -1
    s_waitcnt lgkmcnt(6)
    v_mfma_f32_16x16x32_bf16 v[128:131], a[0:3], v[80:83], 0
    ds_read_b128 v[112:115], v45 offset:8192
    v_mfma_f32_16x16x32_bf16 v[144:147], a[4:7], v[80:83], 0
    buffer_load_dwordx4 v33, s[24:27], s54 offen offset:512 lds
    ds_read_b64_tr_b16 a[52:53], v39 offset:32
    v_mfma_f32_16x16x32_bf16 v[132:135], a[0:3], v[84:87], 0
    ds_read_b128 v[116:119], v46 offset:8192
    v_mfma_f32_16x16x32_bf16 v[148:151], a[4:7], v[84:87], 0
    buffer_load_dwordx4 v34, s[24:27], s54 offen offset:1536 lds
    ds_read_b64_tr_b16 a[54:55], v39 offset:4640
    v_mfma_f32_16x16x32_bf16 v[120:123], a[12:15], v[88:91], v[120:123]
    s_waitcnt vmcnt(8)
    s_barrier
    s_mov_b64 exec, s[74:75]
    buffer_store_byte v6, v7, s[32:35], 0 offen
    s_mov_b64 exec, -1
    ds_read_b128 v[72:75], v43 offset:12288
    v_mfma_f32_16x16x32_bf16 v[136:139], a[16:19], v[88:91], v[136:139]
    buffer_load_dwordx4 v35, s[24:27], s54 offen offset:2560 lds
    ds_read_b64_tr_b16 a[56:57], v42 offset:0
    v_mfma_f32_16x16x32_bf16 v[152:155], a[20:23], v[88:91], v[152:155]
    ds_read_b64_tr_b16 a[58:59], v42 offset:4608
    v_mfma_f32_16x16x32_bf16 v[124:127], a[12:15], v[92:95], v[124:127]
    ds_read_b128 v[76:79], v44 offset:12288
    buffer_load_dwordx4 v36, s[24:27], s54 offen offset:3584 lds
    v_mfma_f32_16x16x32_bf16 v[140:143], a[16:19], v[92:95], v[140:143]
    ds_read_b64_tr_b16 a[60:61], v39 offset:9216
    s_waitcnt lgkmcnt(9)
    v_mfma_f32_16x16x32_bf16 v[128:131], a[12:15], v[96:99], v[128:131]
    ds_read_b128 v[80:83], v45 offset:12288
    v_mfma_f32_16x16x32_bf16 v[144:147], a[16:19], v[96:99], v[144:147]
    ds_read_b64_tr_b16 a[62:63], v39 offset:13824
    v_mfma_f32_16x16x32_bf16 v[132:135], a[12:15], v[100:103], v[132:135]
    ds_read_b128 v[84:87], v46 offset:12288
    v_mfma_f32_16x16x32_bf16 v[148:151], a[16:19], v[100:103], v[148:151]
    ds_read_b64_tr_b16 a[64:65], v39 offset:9248
    v_mfma_f32_16x16x32_bf16 v[120:123], a[24:27], v[104:107], v[120:123]
    ds_read_b64_tr_b16 a[66:67], v39 offset:13856
    v_mfma_f32_16x16x32_bf16 v[136:139], a[28:31], v[104:107], v[136:139]
    ds_read_b64_tr_b16 a[68:69], v42 offset:9216
    v_mfma_f32_16x16x32_bf16 v[152:155], a[32:35], v[104:107], v[152:155]
    ds_read_b64_tr_b16 a[70:71], v42 offset:13824
    v_mfma_f32_16x16x32_bf16 v[124:127], a[24:27], v[108:111], v[124:127]
    ds_read_b64_tr_b16 a[72:73], v39 offset:18432
    v_mfma_f32_16x16x32_bf16 v[140:143], a[28:31], v[108:111], v[140:143]
    ds_read_b64_tr_b16 a[74:75], v39 offset:23040
    s_waitcnt lgkmcnt(10)
    v_mfma_f32_16x16x32_bf16 v[128:131], a[24:27], v[112:115], v[128:131]
    ds_read_b64_tr_b16 a[76:77], v39 offset:18464
    v_mfma_f32_16x16x32_bf16 v[144:147], a[28:31], v[112:115], v[144:147]
    ds_read_b64_tr_b16 a[78:79], v39 offset:23072
    v_mfma_f32_16x16x32_bf16 v[132:135], a[24:27], v[116:119], v[132:135]
    ds_read_b64_tr_b16 a[80:81], v42 offset:18432
    v_mfma_f32_16x16x32_bf16 v[148:151], a[28:31], v[116:119], v[148:151]
    ds_read_b64_tr_b16 a[82:83], v42 offset:23040
    v_mfma_f32_16x16x32_bf16 v[120:123], a[36:39], v[72:75], v[120:123]
    ds_read_b64_tr_b16 a[84:85], v39 offset:27648
    v_mfma_f32_16x16x32_bf16 v[136:139], a[40:43], v[72:75], v[136:139]
    ds_read_b64_tr_b16 a[86:87], v39 offset:32256
    v_mfma_f32_16x16x32_bf16 v[152:155], a[44:47], v[72:75], v[152:155]
    ds_read_b64_tr_b16 a[88:89], v39 offset:27680
    v_mfma_f32_16x16x32_bf16 v[124:127], a[36:39], v[76:79], v[124:127]
    ds_read_b64_tr_b16 a[90:91], v39 offset:32288
    v_mfma_f32_16x16x32_bf16 v[140:143], a[40:43], v[76:79], v[140:143]
    ds_read_b64_tr_b16 a[92:93], v42 offset:27648
    s_waitcnt lgkmcnt(15)
    v_mfma_f32_16x16x32_bf16 v[128:131], a[36:39], v[80:83], v[128:131]
    ds_read_b64_tr_b16 a[94:95], v42 offset:32256
    v_mfma_f32_16x16x32_bf16 v[144:147], a[40:43], v[80:83], v[144:147]
    ds_read_b64_tr_b16 a[96:97], v38 offset:18432
    v_mfma_f32_16x16x32_bf16 v[132:135], a[36:39], v[84:87], v[132:135]
    ds_read_b64_tr_b16 a[98:99], v38 offset:23040
    v_mfma_f32_16x16x32_bf16 v[148:151], a[40:43], v[84:87], v[148:151]
    ds_read_b64_tr_b16 a[100:101], v38 offset:18464
    ds_read_b64_tr_b16 a[102:103], v38 offset:23072
    ds_read_b64_tr_b16 a[104:105], v41 offset:18432
    ds_read_b64_tr_b16 a[106:107], v41 offset:23040
    ds_read_b64_tr_b16 a[108:109], v38 offset:27648
    ds_read_b64_tr_b16 a[110:111], v38 offset:32256
    ds_read_b64_tr_b16 a[112:113], v38 offset:27680
    ds_read_b64_tr_b16 a[114:115], v38 offset:32288
    ds_read_b64_tr_b16 a[116:117], v41 offset:27648
    ds_read_b64_tr_b16 a[118:119], v41 offset:32256
    s_waitcnt vmcnt(0)
    s_cmp_lg_u32 s44, 0
    s_cbranch_scc1 wl_done_9
    v_min_u32 v7, 3, v1
    v_lshl_add_u32 v6, v7, 3, s52
    s_or_b32 s50, s47, 32
    s_mov_b32 s55, 0
wl_fast_10:
    s_cmp_ge_u32 s55, 64
    s_cbranch_scc1 wl_slow_11
    buffer_load_ubyte v8, v6, s[32:35], 0 offen sc1
    s_add_u32 s55, s55, 1
    s_waitcnt vmcnt(0)
    v_and_b32 v9, 39, v8
    v_cmp_ne_u32 vcc, s50, v9
    s_nop 4
    s_cbranch_vccnz wl_fast_10
wl_done_9:
    s_barrier
    s_add_u32 m0, s66, 16384
    s_add_u32 s56, s43, 1
    s_and_b32 s56, s56, 3
    s_lshl_b32 s56, s56, 14
    s_add_u32 s54, s56, s68
    buffer_load_dwordx4 v43, s[36:39], s54 offen sc1 lds
    s_add_u32 m0, m0, 4096
    s_add_u32 s54, s54, 4096
    buffer_load_dwordx4 v43, s[36:39], s54 offen sc1 lds
    s_add_u32 m0, m0, 4096
    s_add_u32 s54, s54, 4096
    buffer_load_dwordx4 v43, s[36:39], s54 offen sc1 lds
    s_add_u32 m0, m0, 4096
    s_add_u32 s54, s54, 4096
    buffer_load_dwordx4 v43, s[36:39], s54 offen sc1 lds
    s_add_u32 m0, m0, 4096
    s_add_u32 s56, s43, 2
    s_and_b32 s56, s56, 3
    s_lshl_b32 s56, s56, 14
    s_add_u32 s54, s56, s68
    buffer_load_dwordx4 v43, s[36:39], s54 offen sc1 lds
    s_add_u32 m0, m0, 4096
    s_add_u32 s54, s54, 4096
    buffer_load_dwordx4 v43, s[36:39], s54 offen sc1 lds
    s_add_u32 m0, m0, 4096
    s_add_u32 s54, s54, 4096
    buffer_load_dwordx4 v43, s[36:39], s54 offen sc1 lds
    s_add_u32 m0, m0, 4096
    s_add_u32 s54, s54, 4096
    buffer_load_dwordx4 v43, s[36:39], s54 offen sc1 lds
    s_add_u32 m0, m0, 4096
    s_add_u32 s56, s43, 3
    s_and_b32 s56, s56, 3
    s_lshl_b32 s56, s56, 14
    s_add_u32 s54, s56, s68
    buffer_load_dwordx4 v43, s[36:39], s54 offen sc1 lds
    ds_read_b64_tr_b16 a[120:121], v38 offset:36864
    ds_read_b64_tr_b16 a[122:123], v38 offset:41472
    ds_read_b64_tr_b16 a[124:125], v38 offset:36896
    ds_read_b64_tr_b16 a[126:127], v38 offset:41504
    ds_read_b64_tr_b16 a[128:129], v41 offset:36864
    ds_read_b64_tr_b16 a[130:131], v41 offset:41472
    ds_read_b64_tr_b16 a[132:133], v38 offset:46080
    ds_read_b64_tr_b16 a[134:135], v38 offset:50688
    ds_read_b64_tr_b16 a[136:137], v38 offset:46112
    ds_read_b64_tr_b16 a[138:139], v38 offset:50720
    ds_read_b64_tr_b16 a[140:141], v41 offset:46080
    ds_read_b64_tr_b16 a[142:143], v41 offset:50688
    ds_read_b64_tr_b16 a[144:145], v38 offset:0
    ds_read_b64_tr_b16 a[146:147], v38 offset:4608
    ds_read_b64_tr_b16 a[148:149], v38 offset:32
    ds_read_b64_tr_b16 a[150:151], v38 offset:4640
    ds_read_b64_tr_b16 a[152:153], v41 offset:0
    ds_read_b64_tr_b16 a[154:155], v41 offset:4608
    ds_read_b64_tr_b16 a[156:157], v38 offset:9216
    ds_read_b64_tr_b16 a[158:159], v38 offset:13824
    ds_read_b64_tr_b16 a[160:161], v38 offset:9248
    ds_read_b64_tr_b16 a[162:163], v38 offset:13856
    ds_read_b64_tr_b16 a[164:165], v41 offset:9216
    ds_read_b64_tr_b16 a[166:167], v41 offset:13824
    v_and_b32 v6, 7, v1
    v_lshrrev_b32 v7, 4, v1
    v_lshl_add_u32 v6, v7, 3, v6
    v_bfe_u32 v7, v1, 3, 1
    v_mul_u32_u24 v7, 24576, v7
    v_lshl_add_u32 v11, v6, 4, v7
    v_lshl_add_u32 v12, v6, 2, v7
    s_lshl_b32 s50, s44, 9
    v_add_u32 v13, s50, v11
    s_lshl_b32 s51, s44, 7
    s_add_u32 s51, s51, 2048
    v_add_u32 v12, s51, v12
    s_mul_i32 s85, s41, 196608
    s_add_u32 s85, s85, 8388608
    s_mul_i32 s86, s40, 24576
    s_add_u32 s86, s86, s85
    s_add_u32 s84, s86, 6144
    s_mul_i32 s52, s40, 3072
    s_add_u32 s52, s52, s85
    s_add_u32 s80, s44, 0
    s_waitcnt lgkmcnt(0)
    s_waitcnt vmcnt(6)
    s_barrier
    s_add_u32 m0, m0, 4096
    s_add_u32 s54, s54, 4096
    buffer_load_dwordx4 v43, s[36:39], s54 offen sc1 lds
    s_add_u32 m0, m0, 4096
    s_add_u32 s54, s54, 4096
    buffer_load_dwordx4 v43, s[36:39], s54 offen sc1 lds
    ds_read_b128 v[72:75], v43 offset:16384
    ds_read_b128 v[76:79], v44 offset:16384
    ds_read_b128 v[80:83], v45 offset:16384
    ds_read_b128 v[84:87], v46 offset:16384
    ds_read_b128 v[88:91], v43 offset:20480
    ds_read_b128 v[92:95], v44 offset:20480
    ds_read_b128 v[96:99], v45 offset:20480
    ds_read_b128 v[100:103], v46 offset:20480
    s_waitcnt lgkmcnt(6)
    v_mfma_f32_16x16x32_bf16 v[120:123], a[48:51], v[72:75], v[120:123]
    s_add_u32 m0, m0, 4096
    ds_read_b128 v[104:107], v43 offset:24576
    s_add_u32 s54, s54, 4096
    v_mfma_f32_16x16x32_bf16 v[136:139], a[52:55], v[72:75], v[136:139]
    s_and_b32 s80, s80, 3
    s_mul_i32 s80, s80, 49152
    s_add_u32 s80, s80, s52
    v_mfma_f32_16x16x32_bf16 v[152:155], a[56:59], v[72:75], v[152:155]
    s_add_u32 s81, s44, 1
    s_and_b32 s81, s81, 3
    s_mul_i32 s81, s81, 49152
    v_mfma_f32_16x16x32_bf16 v[124:127], a[48:51], v[76:79], v[124:127]
    s_add_u32 s81, s81, s52
    ds_read_b128 v[108:111], v44 offset:24576
    buffer_load_dwordx4 v43, s[36:39], s54 offen sc1 lds
    v_mfma_f32_16x16x32_bf16 v[140:143], a[52:55], v[76:79], v[140:143]
    s_add_u32 m0, m0, 4096
    s_add_u32 s54, s68, 65536
    s_waitcnt lgkmcnt(4)
    v_mfma_f32_16x16x32_bf16 v[128:131], a[48:51], v[80:83], v[128:131]
    s_add_u32 s82, s44, 2
    ds_read_b128 v[112:115], v45 offset:24576
    s_and_b32 s82, s82, 3
    v_mfma_f32_16x16x32_bf16 v[144:147], a[52:55], v[80:83], v[144:147]
    s_mul_i32 s82, s82, 49152
    s_add_u32 s82, s82, s52
    s_add_u32 s83, s44, 3
    v_mfma_f32_16x16x32_bf16 v[132:135], a[48:51], v[84:87], v[132:135]
    s_and_b32 s83, s83, 3
    ds_read_b128 v[116:119], v46 offset:24576
    buffer_load_dwordx4 v43, s[36:39], s54 offen sc1 lds
    v_mfma_f32_16x16x32_bf16 v[148:151], a[52:55], v[84:87], v[148:151]
    s_add_u32 m0, m0, 4096
    s_add_u32 s54, s54, 4096
    s_mul_i32 s83, s83, 49152
    v_mfma_f32_16x16x32_bf16 v[120:123], a[60:63], v[88:91], v[120:123]
    s_waitcnt vmcnt(8)
    s_barrier
    s_add_u32 s83, s83, s52
    ds_read_b128 v[72:75], v43 offset:28672
    v_lshrrev_b32 v10, 5, v1
    v_mfma_f32_16x16x32_bf16 v[136:139], a[64:67], v[88:91], v[136:139]
    v_mul_u32_u24 v10, 12288, v10
    v_and_b32 v9, 31, v1
    v_mfma_f32_16x16x32_bf16 v[152:155], a[68:71], v[88:91], v[152:155]
    buffer_load_dwordx4 v43, s[36:39], s54 offen sc1 lds
    s_add_u32 m0, s67, 110592
    v_mfma_f32_16x16x32_bf16 v[124:127], a[60:63], v[92:95], v[124:127]
    s_add_u32 s54, s3, 73728
    ds_read_b128 v[76:79], v44 offset:28672
    v_lshl_add_u32 v16, v9, 4, v10
    v_mfma_f32_16x16x32_bf16 v[140:143], a[64:67], v[92:95], v[140:143]
    v_add_u32 v14, s50, v16
    s_waitcnt lgkmcnt(4)
    v_mfma_f32_16x16x32_bf16 v[128:131], a[60:63], v[96:99], v[128:131]
    ds_read_b128 v[80:83], v45 offset:28672
    v_add_u32 v16, 2560, v16
    v_mfma_f32_16x16x32_bf16 v[144:147], a[64:67], v[96:99], v[144:147]
    s_mov_b32 exec_hi, 0
    buffer_load_dwordx4 v32, s[24:27], s54 offen lds
    s_mov_b32 exec_hi, -1
    v_mfma_f32_16x16x32_bf16 v[132:135], a[60:63], v[100:103], v[132:135]
    ds_read_b128 v[84:87], v46 offset:28672
    v_lshl_add_u32 v15, v9, 2, v10
    v_mfma_f32_16x16x32_bf16 v[148:151], a[64:67], v[100:103], v[148:151]
    v_add_u32 v15, s51, v15
    s_lshl_b32 s53, s42, 3
    v_mfma_f32_16x16x32_bf16 v[120:123], a[72:75], v[104:107], v[120:123]
    s_add_u32 s53, s53, s40
    ds_read_b128 v[88:91], v43 offset:32768
    s_mul_i32 s53, s53, 9216
    v_mfma_f32_16x16x32_bf16 v[136:139], a[76:79], v[104:107], v[136:139]
    buffer_load_dwordx4 v33, s[24:27], s54 offen offset:512 lds
    v_mfma_f32_16x16x32_bf16 v[152:155], a[80:83], v[104:107], v[152:155]
    v_mfma_f32_16x16x32_bf16 v[124:127], a[72:75], v[108:111], v[124:127]
    ds_read_b128 v[92:95], v44 offset:32768
    v_mfma_f32_16x16x32_bf16 v[140:143], a[76:79], v[108:111], v[140:143]
    s_waitcnt lgkmcnt(4)
    v_mfma_f32_16x16x32_bf16 v[128:131], a[72:75], v[112:115], v[128:131]
    ds_read_b128 v[96:99], v45 offset:32768
    v_mfma_f32_16x16x32_bf16 v[144:147], a[76:79], v[112:115], v[144:147]
    v_mfma_f32_16x16x32_bf16 v[132:135], a[72:75], v[116:119], v[132:135]
    ds_read_b128 v[100:103], v46 offset:32768
    buffer_load_dwordx4 v34, s[24:27], s54 offen offset:1536 lds
    v_mfma_f32_16x16x32_bf16 v[148:151], a[76:79], v[116:119], v[148:151]
    v_mfma_f32_16x16x32_bf16 v[120:123], a[84:87], v[72:75], v[120:123]
    s_waitcnt vmcnt(9)
    s_barrier
    ds_read_b128 v[104:107], v43 offset:36864
    v_mfma_f32_16x16x32_bf16 v[136:139], a[88:91], v[72:75], v[136:139]
    v_mfma_f32_16x16x32_bf16 v[152:155], a[92:95], v[72:75], v[152:155]
    v_mfma_f32_16x16x32_bf16 v[124:127], a[84:87], v[76:79], v[124:127]
    ds_read_b128 v[108:111], v44 offset:36864
    v_mfma_f32_16x16x32_bf16 v[140:143], a[88:91], v[76:79], v[140:143]
    buffer_load_dwordx4 v35, s[24:27], s54 offen offset:2560 lds
    s_waitcnt lgkmcnt(4)
    v_mfma_f32_16x16x32_bf16 v[128:131], a[84:87], v[80:83], v[128:131]
    ds_read_b128 v[112:115], v45 offset:36864
    v_mfma_f32_16x16x32_bf16 v[144:147], a[88:91], v[80:83], v[144:147]
    v_mfma_f32_16x16x32_bf16 v[132:135], a[84:87], v[84:87], v[132:135]
    ds_read_b128 v[116:119], v46 offset:36864
    v_mfma_f32_16x16x32_bf16 v[148:151], a[88:91], v[84:87], v[148:151]
    v_mfma_f32_16x16x32_bf16 v[120:123], a[96:99], v[88:91], v[120:123]
    ds_read_b128 v[72:75], v43 offset:40960
    v_mfma_f32_16x16x32_bf16 v[136:139], a[100:103], v[88:91], v[136:139]
    buffer_load_dwordx4 v36, s[24:27], s54 offen offset:3584 lds
    s_add_u32 m0, s67, 129024
    v_mfma_f32_16x16x32_bf16 v[152:155], a[104:107], v[88:91], v[152:155]
    s_mov_b32 s54, s87
    v_mfma_f32_16x16x32_bf16 v[124:127], a[96:99], v[92:95], v[124:127]
    ds_read_b128 v[76:79], v44 offset:40960
    v_mfma_f32_16x16x32_bf16 v[140:143], a[100:103], v[92:95], v[140:143]
    s_waitcnt lgkmcnt(4)
    v_mfma_f32_16x16x32_bf16 v[128:131], a[96:99], v[96:99], v[128:131]
    ds_read_b128 v[80:83], v45 offset:40960
    v_mfma_f32_16x16x32_bf16 v[144:147], a[100:103], v[96:99], v[144:147]
    v_mfma_f32_16x16x32_bf16 v[132:135], a[96:99], v[100:103], v[132:135]
    ds_read_b128 v[84:87], v46 offset:40960
    v_mfma_f32_16x16x32_bf16 v[148:151], a[100:103], v[100:103], v[148:151]
    s_mov_b32 exec_hi, 0
    buffer_load_dwordx4 v32, s[24:27], s54 offen lds
    s_mov_b32 exec_hi, -1
    v_mfma_f32_16x16x32_bf16 v[120:123], a[108:111], v[104:107], v[120:123]
    ds_read_b128 v[88:91], v43 offset:45056
    v_mfma_f32_16x16x32_bf16 v[136:139], a[112:115], v[104:107], v[136:139]
    v_mfma_f32_16x16x32_bf16 v[152:155], a[116:119], v[104:107], v[152:155]
    v_mfma_f32_16x16x32_bf16 v[124:127], a[108:111], v[108:111], v[124:127]
    ds_read_b128 v[92:95], v44 offset:45056
    buffer_load_dwordx4 v33, s[24:27], s54 offen offset:512 lds
    v_mfma_f32_16x16x32_bf16 v[140:143], a[112:115], v[108:111], v[140:143]
    s_waitcnt lgkmcnt(4)
    v_mfma_f32_16x16x32_bf16 v[128:131], a[108:111], v[112:115], v[128:131]
    ds_read_b128 v[96:99], v45 offset:45056
    v_mfma_f32_16x16x32_bf16 v[144:147], a[112:115], v[112:115], v[144:147]
    v_mfma_f32_16x16x32_bf16 v[132:135], a[108:111], v[116:119], v[132:135]
    ds_read_b128 v[100:103], v46 offset:45056
    v_mfma_f32_16x16x32_bf16 v[148:151], a[112:115], v[116:119], v[148:151]
    v_mfma_f32_16x16x32_bf16 v[120:123], a[120:123], v[72:75], v[120:123]
    s_waitcnt vmcnt(7)
    s_barrier
    ds_read_b128 v[104:107], v43 offset:49152
    buffer_load_dwordx4 v34, s[24:27], s54 offen offset:1536 lds
    v_mfma_f32_16x16x32_bf16 v[136:139], a[124:127], v[72:75], v[136:139]
    v_mfma_f32_16x16x32_bf16 v[152:155], a[128:131], v[72:75], v[152:155]
    v_mfma_f32_16x16x32_bf16 v[124:127], a[120:123], v[76:79], v[124:127]
    ds_read_b128 v[108:111], v43 offset:53248
    v_mfma_f32_16x16x32_bf16 v[140:143], a[124:127], v[76:79], v[140:143]
    s_waitcnt lgkmcnt(4)
    v_mfma_f32_16x16x32_bf16 v[128:131], a[120:123], v[80:83], v[128:131]
    ds_read_b128 v[112:115], v43 offset:57344
    v_mfma_f32_16x16x32_bf16 v[144:147], a[124:127], v[80:83], v[144:147]
    buffer_load_dwordx4 v35, s[24:27], s54 offen offset:2560 lds
    v_mfma_f32_16x16x32_bf16 v[132:135], a[120:123], v[84:87], v[132:135]
    ds_read_b128 v[116:119], v43 offset:61440
    v_mfma_f32_16x16x32_bf16 v[148:151], a[124:127], v[84:87], v[148:151]
    v_mfma_f32_16x16x32_bf16 v[120:123], a[132:135], v[88:91], v[120:123]
    ds_read_b128 v[72:75], v47 offset:0
    v_mfma_f32_16x16x32_bf16 v[136:139], a[136:139], v[88:91], v[136:139]
    v_mfma_f32_16x16x32_bf16 v[152:155], a[140:143], v[88:91], v[152:155]
    v_mfma_f32_16x16x32_bf16 v[124:127], a[132:135], v[92:95], v[124:127]
    ds_read_b128 v[76:79], v47 offset:4096
    buffer_load_dwordx4 v36, s[24:27], s54 offen offset:3584 lds
    v_mfma_f32_16x16x32_bf16 v[140:143], a[136:139], v[92:95], v[140:143]
    s_waitcnt lgkmcnt(4)
    v_mfma_f32_16x16x32_bf16 v[128:131], a[132:135], v[96:99], v[128:131]
    s_waitcnt vmcnt(5)
    s_barrier
    ds_read_b128 v[80:83], v44 offset:49152
    v_mfma_f32_16x16x32_bf16 v[144:147], a[136:139], v[96:99], v[144:147]
    ds_read_b64_tr_b16 a[168:169], v39 offset:0
    v_mfma_f32_16x16x32_bf16 v[132:135], a[132:135], v[100:103], v[132:135]
    ds_read_b128 v[84:87], v44 offset:53248
    v_mfma_f32_16x16x32_bf16 v[148:151], a[136:139], v[100:103], v[148:151]
    ds_read_b64_tr_b16 a[170:171], v39 offset:4608
    v_mfma_f32_16x16x32_bf16 v[120:123], a[144:147], v[104:107], v[120:123]
    ds_read_b128 v[88:91], v44 offset:57344
    v_mfma_f32_16x16x32_bf16 v[136:139], a[148:151], v[104:107], v[136:139]
    ds_read_b64_tr_b16 a[172:173], v39 offset:32
    v_mfma_f32_16x16x32_bf16 v[152:155], a[152:155], v[104:107], v[152:155]
    ds_read_b64_tr_b16 a[174:175], v39 offset:4640
    v_mfma_f32_16x16x32_bf16 v[120:123], a[156:159], v[108:111], v[120:123]
    s_waitcnt vmcnt(0)
    s_barrier
    ds_read_b128 v[92:95], v44 offset:61440
    v_mfma_f32_16x16x32_bf16 v[136:139], a[160:163], v[108:111], v[136:139]
    ds_read_b64_tr_b16 a[176:177], v42 offset:0
    v_mfma_f32_16x16x32_bf16 v[152:155], a[164:167], v[108:111], v[152:155]
    ds_read_b64_tr_b16 a[178:179], v42 offset:4608
    s_waitcnt lgkmcnt(0)
    v_mfma_f32_16x16x32_bf16 v[120:123], a[168:171], v[112:115], v[120:123]
    ds_read_b128 v[96:99], v48 offset:0
    v_mfma_f32_16x16x32_bf16 v[136:139], a[172:175], v[112:115], v[136:139]
    ds_read_b64_tr_b16 a[180:181], v39 offset:9216
    v_mfma_f32_16x16x32_bf16 v[152:155], a[176:179], v[112:115], v[152:155]
    ds_read_b64_tr_b16 a[182:183], v39 offset:13824
    ds_read_b64_tr_b16 a[184:185], v39 offset:9248
    ds_read_b64_tr_b16 a[186:187], v39 offset:13856
    ds_read_b64_tr_b16 a[188:189], v42 offset:9216
    ds_read_b64_tr_b16 a[190:191], v42 offset:13824
    s_waitcnt lgkmcnt(0)
    v_mfma_f32_16x16x32_bf16 v[120:123], a[180:183], v[116:119], v[120:123]
    ds_read_b128 v[100:103], v48 offset:4096
    v_mfma_f32_16x16x32_bf16 v[136:139], a[184:187], v[116:119], v[136:139]
    ds_read_b64_tr_b16 a[192:193], v39 offset:18432
    v_mfma_f32_16x16x32_bf16 v[152:155], a[188:191], v[116:119], v[152:155]
    ds_read_b64_tr_b16 a[194:195], v39 offset:23040
    ds_read_b64_tr_b16 a[196:197], v39 offset:18464
    ds_read_b64_tr_b16 a[198:199], v39 offset:23072
    ds_read_b64_tr_b16 a[200:201], v42 offset:18432
    ds_read_b64_tr_b16 a[202:203], v42 offset:23040
    s_waitcnt lgkmcnt(0)
    v_mfma_f32_16x16x32_bf16 v[120:123], a[192:195], v[72:75], v[120:123]
    ds_read_b128 v[104:107], v45 offset:49152
    v_mfma_f32_16x16x32_bf16 v[136:139], a[196:199], v[72:75], v[136:139]
    ds_read_b64_tr_b16 a[204:205], v39 offset:27648
    v_mfma_f32_16x16x32_bf16 v[152:155], a[200:203], v[72:75], v[152:155]
    ds_read_b64_tr_b16 a[206:207], v39 offset:32256
    ds_read_b64_tr_b16 a[208:209], v39 offset:27680
    ds_read_b64_tr_b16 a[210:211], v39 offset:32288
    ds_read_b64_tr_b16 a[212:213], v42 offset:27648
    ds_read_b64_tr_b16 a[214:215], v42 offset:32256
    s_waitcnt lgkmcnt(0)
    v_mfma_f32_16x16x32_bf16 v[120:123], a[204:207], v[76:79], v[120:123]
    ds_read_b128 v[108:111], v45 offset:53248
    v_mfma_f32_16x16x32_bf16 v[136:139], a[208:211], v[76:79], v[136:139]
    v_mfma_f32_16x16x32_bf16 v[152:155], a[212:215], v[76:79], v[152:155]
    v_mfma_f32_16x16x32_bf16 v[124:127], a[144:147], v[80:83], v[124:127]
    ds_read_b128 v[112:115], v45 offset:57344
    v_mfma_f32_16x16x32_bf16 v[140:143], a[148:151], v[80:83], v[140:143]
    v_mfma_f32_16x16x32_bf16 v[124:127], a[156:159], v[84:87], v[124:127]
    ds_read_b128 v[116:119], v45 offset:61440
    v_mfma_f32_16x16x32_bf16 v[140:143], a[160:163], v[84:87], v[140:143]
    v_mfma_f32_16x16x32_bf16 v[124:127], a[168:171], v[88:91], v[124:127]
    ds_read_b128 v[72:75], v49 offset:0
    v_cvt_pk_bf16_f32 v176, v120, v121
    v_mfma_f32_16x16x32_bf16 v[140:143], a[172:175], v[88:91], v[140:143]
    v_cvt_pk_bf16_f32 v177, v122, v123
    v_cvt_pk_bf16_f32 v178, v136, v137
    v_mfma_f32_16x16x32_bf16 v[124:127], a[180:183], v[92:95], v[124:127]
    ds_read_b128 v[76:79], v49 offset:4096
    v_cvt_pk_bf16_f32 v179, v138, v139
    v_mfma_f32_16x16x32_bf16 v[140:143], a[184:187], v[92:95], v[140:143]
    buffer_store_dwordx4 v[176:179], v13, s[36:39], s80 offen sc1
    s_waitcnt lgkmcnt(4)
    v_mfma_f32_16x16x32_bf16 v[124:127], a[192:195], v[96:99], v[124:127]
    ds_read_b128 v[80:83], v46 offset:49152
    v_bitop3_b32 v194, v176, v177, v178 bitop3:0x96
    v_mfma_f32_16x16x32_bf16 v[140:143], a[196:199], v[96:99], v[140:143]
    v_bitop3_b32 v194, v194, v179, s48 bitop3:0x96
    v_cvt_pk_bf16_f32 v192, v152, v153
    v_mfma_f32_16x16x32_bf16 v[124:127], a[204:207], v[100:103], v[124:127]
    ds_read_b128 v[84:87], v46 offset:53248
    v_cvt_pk_bf16_f32 v193, v154, v155
    v_mfma_f32_16x16x32_bf16 v[140:143], a[208:211], v[100:103], v[140:143]
    v_bitop3_b32 v194, v194, v192, v193 bitop3:0x96
    buffer_store_dwordx4 v[192:195], v11, s[36:39], s80 offen offset:2560 sc1
    v_mfma_f32_16x16x32_bf16 v[128:131], a[144:147], v[104:107], v[128:131]
    ds_read_b128 v[88:91], v46 offset:57344
    v_mfma_f32_16x16x32_bf16 v[144:147], a[148:151], v[104:107], v[144:147]
    v_mfma_f32_16x16x32_bf16 v[128:131], a[156:159], v[108:111], v[128:131]
    ds_read_b128 v[92:95], v46 offset:61440
    v_mfma_f32_16x16x32_bf16 v[144:147], a[160:163], v[108:111], v[144:147]
    s_waitcnt lgkmcnt(4)
    v_mfma_f32_16x16x32_bf16 v[128:131], a[168:171], v[112:115], v[128:131]
    ds_read_b128 v[96:99], v50 offset:0
    v_cvt_pk_bf16_f32 v180, v124, v125
    v_mfma_f32_16x16x32_bf16 v[144:147], a[172:175], v[112:115], v[144:147]
    v_cvt_pk_bf16_f32 v181, v126, v127
    v_cvt_pk_bf16_f32 v182, v140, v141
    v_mfma_f32_16x16x32_bf16 v[128:131], a[180:183], v[116:119], v[128:131]
    ds_read_b128 v[100:103], v50 offset:4096
    v_cvt_pk_bf16_f32 v183, v142, v143
    v_mfma_f32_16x16x32_bf16 v[144:147], a[184:187], v[116:119], v[144:147]
    buffer_store_dwordx4 v[180:183], v13, s[36:39], s81 offen sc1
    v_bitop3_b32 v197, v180, v181, v182 bitop3:0x96
    v_mfma_f32_16x16x32_bf16 v[128:131], a[192:195], v[72:75], v[128:131]
    v_bitop3_b32 v197, v197, v183, s48 bitop3:0x96
    buffer_store_dword v197, v12, s[36:39], s81 offen sc1
    v_mfma_f32_16x16x32_bf16 v[144:147], a[196:199], v[72:75], v[144:147]
    v_mfma_f32_16x16x32_bf16 v[128:131], a[204:207], v[76:79], v[128:131]
    v_mfma_f32_16x16x32_bf16 v[144:147], a[208:211], v[76:79], v[144:147]
    s_waitcnt lgkmcnt(2)
    v_mfma_f32_16x16x32_bf16 v[132:135], a[144:147], v[80:83], v[132:135]
    v_mfma_f32_16x16x32_bf16 v[148:151], a[148:151], v[80:83], v[148:151]
    v_mfma_f32_16x16x32_bf16 v[132:135], a[156:159], v[84:87], v[132:135]
    v_mfma_f32_16x16x32_bf16 v[148:151], a[160:163], v[84:87], v[148:151]
    v_mfma_f32_16x16x32_bf16 v[132:135], a[168:171], v[88:91], v[132:135]
    s_nop 0
    v_cvt_pk_bf16_f32 v184, v128, v129
    v_cvt_pk_bf16_f32 v185, v130, v131
    v_mfma_f32_16x16x32_bf16 v[148:151], a[172:175], v[88:91], v[148:151]
    v_cvt_pk_bf16_f32 v186, v144, v145
    v_cvt_pk_bf16_f32 v187, v146, v147
    v_mfma_f32_16x16x32_bf16 v[132:135], a[180:183], v[92:95], v[132:135]
    buffer_store_dwordx4 v[184:187], v13, s[36:39], s82 offen sc1
    v_bitop3_b32 v198, v184, v185, v186 bitop3:0x96
    v_mfma_f32_16x16x32_bf16 v[148:151], a[184:187], v[92:95], v[148:151]
    v_bitop3_b32 v198, v198, v187, s48 bitop3:0x96
    s_waitcnt lgkmcnt(0)
    v_mfma_f32_16x16x32_bf16 v[132:135], a[192:195], v[96:99], v[132:135]
    buffer_store_dword v198, v12, s[36:39], s82 offen sc1
    v_mfma_f32_16x16x32_bf16 v[148:151], a[196:199], v[96:99], v[148:151]
    v_mfma_f32_16x16x32_bf16 v[132:135], a[204:207], v[100:103], v[132:135]
    v_mfma_f32_16x16x32_bf16 v[148:151], a[208:211], v[100:103], v[148:151]
    s_nop 6
    v_cvt_pk_bf16_f32 v188, v132, v133
    v_cvt_pk_bf16_f32 v189, v134, v135
    v_cvt_pk_bf16_f32 v190, v148, v149
    v_cvt_pk_bf16_f32 v191, v150, v151
    buffer_store_dwordx4 v[188:191], v13, s[36:39], s83 offen sc1
    v_bitop3_b32 v199, v188, v189, v190 bitop3:0x96
    v_bitop3_b32 v199, v199, v191, s48 bitop3:0x96
    buffer_store_dword v199, v12, s[36:39], s83 offen sc1
    s_lshr_b32 s50, s40, 1
    s_cmp_lg_u32 s44, s50
    s_cbranch_scc1 fin_12
    s_mov_b32 s55, 0
inb_14:
    buffer_load_dwordx4 v[72:75], v14, s[36:39], s86 offen offset:0 sc1
    buffer_load_dwordx3 v[88:90], v16, s[36:39], s86 offen offset:0 sc1
    buffer_load_dwordx4 v[76:79], v14, s[36:39], s86 offen offset:3072 sc1
    buffer_load_dwordx3 v[92:94], v16, s[36:39], s86 offen offset:3072 sc1
    buffer_load_dwordx4 v[80:83], v14, s[36:39], s84 offen offset:0 sc1
    buffer_load_dwordx3 v[96:98], v16, s[36:39], s84 offen offset:0 sc1
    buffer_load_dwordx4 v[84:87], v14, s[36:39], s84 offen offset:3072 sc1
    buffer_load_dwordx3 v[100:102], v16, s[36:39], s84 offen offset:3072 sc1
    s_add_u32 s55, s55, 1
    v_mov_b32 v6, 0
    s_waitcnt vmcnt(0)
    v_bitop3_b32 v90, v90, v72, v73 bitop3:0x96
    v_bitop3_b32 v90, v90, v74, v75 bitop3:0x96
    v_bitop3_b32 v90, v90, v88, v89 bitop3:0x96
    v_bitop3_b32 v6, v90, s48, v6 bitop3:0xbe
    v_bitop3_b32 v94, v94, v76, v77 bitop3:0x96
    v_bitop3_b32 v94, v94, v78, v79 bitop3:0x96
    v_bitop3_b32 v94, v94, v92, v93 bitop3:0x96
    v_bitop3_b32 v6, v94, s48, v6 bitop3:0xbe
    v_bitop3_b32 v98, v98, v80, v81 bitop3:0x96
    v_bitop3_b32 v98, v98, v82, v83 bitop3:0x96
    v_bitop3_b32 v98, v98, v96, v97 bitop3:0x96
    v_bitop3_b32 v6, v98, s48, v6 bitop3:0xbe
    v_bitop3_b32 v102, v102, v84, v85 bitop3:0x96
    v_bitop3_b32 v102, v102, v86, v87 bitop3:0x96
    v_bitop3_b32 v102, v102, v100, v101 bitop3:0x96
    v_bitop3_b32 v6, v102, s48, v6 bitop3:0xbe
    v_cmp_ne_u32 vcc, 0, v6
    s_nop 4
    s_cbranch_vccz inbdone_15
    s_cmp_lt_u32 s55, 0x20000
    s_cbranch_scc1 inb_14
inbdone_15:
    v_lshlrev_b32 v120, 16, v88
    v_and_b32 v121, 0xffff0000, v88
    v_lshlrev_b32 v122, 16, v89
    v_and_b32 v123, 0xffff0000, v89
    v_lshlrev_b32 v124, 16, v92
    v_and_b32 v125, 0xffff0000, v92
    v_lshlrev_b32 v126, 16, v93
    v_and_b32 v127, 0xffff0000, v93
    v_pk_add_f32 v[120:121], v[120:121], v[124:125]
    v_pk_add_f32 v[122:123], v[122:123], v[126:127]
    v_lshlrev_b32 v124, 16, v96
    v_and_b32 v125, 0xffff0000, v96
    v_lshlrev_b32 v126, 16, v97
    v_and_b32 v127, 0xffff0000, v97
    v_pk_add_f32 v[120:121], v[120:121], v[124:125]
    v_pk_add_f32 v[122:123], v[122:123], v[126:127]
    v_lshlrev_b32 v124, 16, v100
    v_and_b32 v125, 0xffff0000, v100
    v_lshlrev_b32 v126, 16, v101
    v_and_b32 v127, 0xffff0000, v101
    v_pk_add_f32 v[120:121], v[120:121], v[124:125]
    v_pk_add_f32 v[122:123], v[122:123], v[126:127]
    s_nop 1
    v_permlane32_swap_b32 v120, v122
    v_permlane32_swap_b32 v121, v123
    v_lshlrev_b32 v124, 16, v242
    v_and_b32 v125, 0xffff0000, v242
    v_pk_add_f32 v[120:121], v[120:121], v[122:123]
    v_cvt_pk_bf16_f32 v170, v120, v121
    v_lshlrev_b32 v120, 16, v170
    v_and_b32 v121, 0xffff0000, v170
    v_pk_add_f32 v[120:121], v[120:121], v[124:125]
    v_cvt_pk_bf16_f32 v170, v120, v121
    buffer_store_dword v170, v54, s[28:31], s53 offen
    s_branch fin_13
fin_12:
    s_mov_b32 s55, 0
    s_waitcnt vmcnt(0)
inb_16:
    buffer_load_dwordx4 v[72:75], v14, s[36:39], s86 offen offset:0 sc1
    buffer_load_dword v90, v15, s[36:39], s86 offen offset:0 sc1
    buffer_load_dwordx4 v[76:79], v14, s[36:39], s86 offen offset:3072 sc1
    buffer_load_dword v94, v15, s[36:39], s86 offen offset:3072 sc1
    buffer_load_dwordx4 v[80:83], v14, s[36:39], s84 offen offset:0 sc1
    buffer_load_dword v98, v15, s[36:39], s84 offen offset:0 sc1
    buffer_load_dwordx4 v[84:87], v14, s[36:39], s84 offen offset:3072 sc1
    buffer_load_dword v102, v15, s[36:39], s84 offen offset:3072 sc1
    s_add_u32 s55, s55, 1
    v_mov_b32 v6, 0
    s_waitcnt vmcnt(0)
    v_bitop3_b32 v90, v90, v72, v73 bitop3:0x96
    v_bitop3_b32 v90, v90, v74, v75 bitop3:0x96
    v_bitop3_b32 v6, v90, s48, v6 bitop3:0xbe
    v_bitop3_b32 v94, v94, v76, v77 bitop3:0x96
    v_bitop3_b32 v94, v94, v78, v79 bitop3:0x96
    v_bitop3_b32 v6, v94, s48, v6 bitop3:0xbe
    v_bitop3_b32 v98, v98, v80, v81 bitop3:0x96
    v_bitop3_b32 v98, v98, v82, v83 bitop3:0x96
    v_bitop3_b32 v6, v98, s48, v6 bitop3:0xbe
    v_bitop3_b32 v102, v102, v84, v85 bitop3:0x96
    v_bitop3_b32 v102, v102, v86, v87 bitop3:0x96
    v_bitop3_b32 v6, v102, s48, v6 bitop3:0xbe
    v_cmp_ne_u32 vcc, 0, v6
    s_nop 4
    s_cbranch_vccz inbdone_17
    s_cmp_lt_u32 s55, 0x20000
    s_cbranch_scc1 inb_16
inbdone_17:
fin_13:
    v_lshlrev_b32 v120, 16, v72
    v_and_b32 v121, 0xffff0000, v72
    v_lshlrev_b32 v122, 16, v73
    v_and_b32 v123, 0xffff0000, v73
    v_lshlrev_b32 v124, 16, v74
    v_and_b32 v125, 0xffff0000, v74
    v_lshlrev_b32 v126, 16, v75
    v_and_b32 v127, 0xffff0000, v75
    v_lshlrev_b32 v128, 16, v76
    v_and_b32 v129, 0xffff0000, v76
    v_lshlrev_b32 v130, 16, v77
    v_and_b32 v131, 0xffff0000, v77
    v_lshlrev_b32 v132, 16, v78
    v_and_b32 v133, 0xffff0000, v78
    v_lshlrev_b32 v134, 16, v79
    v_and_b32 v135, 0xffff0000, v79
    v_pk_add_f32 v[120:121], v[120:121], v[128:129]
    v_pk_add_f32 v[122:123], v[122:123], v[130:131]
    v_pk_add_f32 v[124:125], v[124:125], v[132:133]
    v_pk_add_f32 v[126:127], v[126:127], v[134:135]
    v_lshlrev_b32 v128, 16, v80
    v_and_b32 v129, 0xffff0000, v80
    v_lshlrev_b32 v130, 16, v81
    v_and_b32 v131, 0xffff0000, v81
    v_lshlrev_b32 v132, 16, v82
    v_and_b32 v133, 0xffff0000, v82
    v_lshlrev_b32 v134, 16, v83
    v_and_b32 v135, 0xffff0000, v83
    v_pk_add_f32 v[120:121], v[120:121], v[128:129]
    v_pk_add_f32 v[122:123], v[122:123], v[130:131]
    v_pk_add_f32 v[124:125], v[124:125], v[132:133]
    v_pk_add_f32 v[126:127], v[126:127], v[134:135]
    v_lshlrev_b32 v128, 16, v84
    v_and_b32 v129, 0xffff0000, v84
    v_lshlrev_b32 v130, 16, v85
    v_and_b32 v131, 0xffff0000, v85
    v_lshlrev_b32 v132, 16, v86
    v_and_b32 v133, 0xffff0000, v86
    v_lshlrev_b32 v134, 16, v87
    v_and_b32 v135, 0xffff0000, v87
    v_pk_add_f32 v[120:121], v[120:121], v[128:129]
    v_pk_add_f32 v[122:123], v[122:123], v[130:131]
    v_pk_add_f32 v[124:125], v[124:125], v[132:133]
    v_pk_add_f32 v[126:127], v[126:127], v[134:135]
    s_nop 0
    v_permlane32_swap_b32 v120, v124
    v_permlane32_swap_b32 v121, v125
    v_permlane32_swap_b32 v122, v126
    v_permlane32_swap_b32 v123, v127
    v_lshlrev_b32 v128, 16, v240
    v_and_b32 v129, 0xffff0000, v240
    v_lshlrev_b32 v130, 16, v241
    v_and_b32 v131, 0xffff0000, v241
    v_pk_add_f32 v[120:121], v[120:121], v[124:125]
    v_pk_add_f32 v[122:123], v[122:123], v[126:127]
    v_cvt_pk_bf16_f32 v168, v120, v121
    v_cvt_pk_bf16_f32 v169, v122, v123
    v_lshlrev_b32 v120, 16, v168
    v_and_b32 v121, 0xffff0000, v168
    v_lshlrev_b32 v122, 16, v169
    v_and_b32 v123, 0xffff0000, v169
    v_pk_add_f32 v[120:121], v[120:121], v[128:129]
    v_pk_add_f32 v[122:123], v[122:123], v[130:131]
    v_cvt_pk_bf16_f32 v168, v120, v121
    v_cvt_pk_bf16_f32 v169, v122, v123
    buffer_store_dwordx2 v[168:169], v53, s[28:31], s53 offen
    s_or_b32 s50, s40, s43
    s_or_b32 s50, s50, s44
    s_cmp_lg_u32 s50, 0
    s_cbranch_scc1 fin_18
    s_lshl_b32 s50, s42, 15
    v_mov_b32 v6, s50
    v_mov_b32 v7, s48
    s_mov_b64 exec, 1
    buffer_store_dword v7, v6, s[36:39], 0 offen sc1
fin_18:
L_end:
    s_endpgm
    s_nop 7
    s_nop 7
wl_slow_3:
    buffer_wbl2 sc1
    v_lshl_add_u32 v7, v7, 7, s58
    s_waitcnt vmcnt(0)
    s_lshl_b32 s51, s46, 7
    s_add_u32 s51, s51, s58
    v_mov_b32 v8, s51
    v_mov_b32 v9, s49
    s_mov_b64 exec, 1
    buffer_store_dword v9, v8, s[36:39], 0 offen sc1
    s_mov_b64 exec, -1
wl_poll_19:
    buffer_load_ubyte v8, v6, s[32:35], 0 offen sc1
    buffer_load_dword v9, v7, s[36:39], 0 offen sc1
    s_waitcnt vmcnt(0)
    v_and_b32 v8, 23, v8
    v_cmp_ne_u32 vcc, s50, v8
    v_cmp_ne_u32 s[62:63], s49, v9
    s_nop 1
    s_and_b64 vcc, vcc, s[62:63]
    s_nop 0
    s_cbranch_vccz wl_pub_20
    s_add_u32 s55, s55, 1
    s_cmp_lt_u32 s55, 0x20000
    s_cbranch_scc1 wl_poll_19
wl_pub_20:
    buffer_inv sc1
    s_waitcnt vmcnt(0)
    s_branch wl_done_1
    s_nop 7
    s_nop 7
recslow_7:
    s_mov_b32 s55, 0
recpoll_21:
    buffer_load_dwordx4 v[200:203], v14, s[36:39], s78 offen sc1
    buffer_load_dwordx4 v[204:207], v14, s[36:39], s78 offen offset:2048 sc1
    buffer_load_dwordx4 v[208:211], v15, s[36:39], s78 offen sc1
    s_add_u32 s55, s55, 1
    s_waitcnt vmcnt(0)
    v_xor_b32 v16, s48, v200
    v_xor_b32 v9, s48, v203
    v_or_b32 v16, v16, v9
    v_xor_b32 v9, s48, v204
    v_or_b32 v16, v16, v9
    v_xor_b32 v9, s48, v207
    v_or_b32 v16, v16, v9
    v_xor_b32 v9, s48, v208
    v_or_b32 v16, v16, v9
    v_xor_b32 v9, s48, v211
    v_or_b32 v16, v16, v9
    v_cmp_ne_u32 vcc, 0, v16
    s_cmp_lt_u32 s55, 0x20000
    s_cselect_b64 s[62:63], -1, 0
    s_and_b64 vcc, vcc, s[62:63]
    s_nop 1
    s_cbranch_vccnz recpoll_21
    v_add_f32 v168, v201, v205
    v_add_f32 v169, v202, v206
    v_mov_b32 v170, v168
    v_mov_b32 v171, v169
    s_nop 0
    v_permlane32_swap_b32 v168, v170
    v_permlane32_swap_b32 v169, v171
    v_add_f32 v168, v168, v170
    v_add_f32 v169, v169, v171
    v_mov_b32 v170, v168
    v_mov_b32 v171, v169
    s_nop 0
    v_permlane16_swap_b32 v168, v170
    v_permlane16_swap_b32 v169, v171
    v_add_f32 v168, v168, v170
    v_add_f32 v169, v169, v171
    v_add_f32 v168, v168, v209
    v_add_f32 v169, v169, v210
    v_mul_f32 v168, 0x3ae38e39, v168
    v_mul_f32 v169, 0x3ae38e39, v169
    v_fma_f32 v169, -v168, v168, v169
    v_max_f32 v169, 0, v169
    v_cvt_pk_bf16_f32 v8, v168, v169
    v_lshlrev_b32 v168, 16, v8
    v_and_b32 v169, 0xffff0000, v8
    v_add_f32 v169, 0x3727c5ac, v169
    v_cvt_pk_bf16_f32 v8, v169, v169
    v_lshlrev_b32 v169, 16, v8
    v_sqrt_f32 v169, v169
    s_nop 0
    v_cvt_pk_bf16_f32 v8, v169, v169
    v_lshlrev_b32 v169, 16, v8
    v_rcp_f32 v8, v169
    s_nop 0
    v_mul_f32 v169, -v168, v8
    v_mov_b32 v168, v8
    s_branch recdone_8
    s_nop 7
    s_nop 7
wl_slow_11:
    buffer_wbl2 sc1
    v_lshl_add_u32 v7, v7, 7, s58
    s_waitcnt vmcnt(0)
    s_lshl_b32 s51, s43, 7
    s_add_u32 s51, s51, s58
    v_mov_b32 v8, s51
    v_mov_b32 v9, s48
    s_mov_b64 exec, 1
    buffer_store_dword v9, v8, s[36:39], 0 offen sc1
    s_mov_b64 exec, -1
wl_poll_22:
    buffer_load_ubyte v8, v6, s[32:35], 0 offen sc1
    buffer_load_dword v9, v7, s[36:39], 0 offen sc1
    s_waitcnt vmcnt(0)
    v_and_b32 v8, 39, v8
    v_cmp_ne_u32 vcc, s50, v8
    v_cmp_ne_u32 s[62:63], s48, v9
    s_nop 1
    s_and_b64 vcc, vcc, s[62:63]
    s_nop 0
    s_cbranch_vccz wl_pub_23
    s_add_u32 s55, s55, 1
    s_cmp_lt_u32 s55, 0x20000
    s_cbranch_scc1 wl_poll_22
wl_pub_23:
    buffer_inv sc1
    s_waitcnt vmcnt(0)
    s_branch wl_done_9
.section .rodata,"a"
.p2align 6
.amdhsa_kernel standalone__mixer_s_mlp__sampling_kernel
  .amdhsa_next_free_vgpr 512
  .amdhsa_next_free_sgpr 102
  .amdhsa_accum_offset 256
  .amdhsa_group_segment_fixed_size 0
  .amdhsa_kernarg_size 64
  .amdhsa_user_sgpr_count 2
  .amdhsa_user_sgpr_kernarg_segment_ptr 1
  .amdhsa_system_sgpr_workgroup_id_x 1
.end_amdhsa_kernel
```
